```python
import torch

def _softmax(x, axis=-1):
    return torch.softmax(x, dim=axis)
def _gelu(x):
    return torch.nn.functional.gelu(x, approximate="tanh")
def _silu(x):
    return torch.nn.functional.silu(x)
def _sigmoid(x):
    return torch.sigmoid(x)
def _layernorm(x, axis=-1, eps=1e-5):
    m = x.mean(dim=axis, keepdim=True)
    v = x.var(dim=axis, keepdim=True, unbiased=False)
    return (x - m) / torch.sqrt(v + eps)
def _scatter_add(tgt, idx, src, axis=0):
    return tgt.clone().index_add_(axis, idx, src)
def _segment_sum(src, seg, n):
    out = torch.zeros((n,) + src.shape[1:], dtype=src.dtype)
    return out.index_add_(0, seg, src)
def _pad(x, pw):
    flat = tuple(v for pair in reversed(pw) for v in pair)
    return torch.nn.functional.pad(x, flat)

kernel_name = 'sequential_preLN__grouped_kv_mqa__mixer_token_mlp__prompt'

def setup_inputs():

    _w = (lambda a: (lambda t: t.to(torch.bfloat16) if t.is_floating_point() else t)(torch.as_tensor(a)))
    def _A_setup():
        B, S, D, H = 1, 2048, 448, 16
        Dh = D // H
        return {
            "x": _w((lambda *s: torch.randn(*s, dtype=torch.bfloat16) * 0.05)(B, S, D)),
            "wq": _w((lambda *s: torch.randn(*s, dtype=torch.bfloat16) * 0.05)(D, H * Dh)),
            "wk": _w((lambda *s: torch.randn(*s, dtype=torch.bfloat16) * 0.05)(D, Dh)),
            "wv": _w((lambda *s: torch.randn(*s, dtype=torch.bfloat16) * 0.05)(D, Dh)),
            "wo": _w((lambda *s: torch.randn(*s, dtype=torch.bfloat16) * 0.05)(H * Dh, D)),
        }
    _A_in = _A_setup()

    def _B_setup():
        B, S, D, F = 1, 2048, 448, 1792
        return {
            "x": _w((lambda *s: torch.randn(*s, dtype=torch.bfloat16) * 0.05)(B, S, D)),
            "w1": _w((lambda *s: torch.randn(*s, dtype=torch.bfloat16) * 0.8)(S, F) * (S ** -0.5)),
            "b1": _w((lambda *s: torch.randn(*s, dtype=torch.bfloat16) * 12.8)(F) * 0.02),
            "w2": _w((lambda *s: torch.randn(*s, dtype=torch.bfloat16) * 0.2)(F, S) * (F ** -0.5)),
            "b2": _w((lambda *s: torch.randn(*s, dtype=torch.bfloat16) * 3.2)(S) * 0.02),
        }
    _B_in = _B_setup()

    return {
        "A_x": _A_in["x"],
        "A_wq": _A_in["wq"],
        "A_wk": _A_in["wk"],
        "A_wv": _A_in["wv"],
        "A_wo": _A_in["wo"],
        "B_x": _B_in["x"],
        "B_w1": _B_in["w1"],
        "B_b1": _B_in["b1"],
        "B_w2": _B_in["w2"],
        "B_b2": _B_in["b2"],
    }

def reference(A_x, A_wq, A_wk, A_wv, A_wo, B_x, B_w1, B_b1, B_w2, B_b2):
    def _A_ref(x, wq, wk, wv, wo):
        B, S, D = x.shape
        H = 16
        Dh = D // H
        q = (lambda x, *d: x.permute(*d))((x @ wq).reshape(B, S, H, Dh), 0, 2, 1, 3)
        k = x @ wk
        v = x @ wv
        scores = torch.einsum("bhqd,bkd->bhqk", q, k) * (Dh ** -0.5)
        p = _softmax(scores, axis=-1)
        o = torch.einsum("bhqk,bkd->bhqd", p, v)
        return (lambda x, *d: x.permute(*d))(o, 0, 2, 1, 3).reshape(B, S, H * Dh) @ wo

    def _B_ref(x, w1, b1, w2, b2):
        B, S, D = x.shape
        h = _layernorm(x, axis=-1)
        u = torch.einsum("bsd,sf->bdf", h, w1) + b1
        u = _gelu(u)
        y = torch.einsum("bdf,fs->bds", u, w2) + b2
        return (lambda x, *d: x.permute(*d))(y, 0, 2, 1)

    x = A_x
    h = x + _A_ref(_layernorm(x, axis=-1), A_wq, A_wk, A_wv, A_wo)
    h2 = h + _B_ref(_layernorm(h, axis=-1), B_w1, B_b1, B_w2, B_b2)
    return h2
```

```asm
; @launch kernel=k1_kernel grid=(192,1,1) block=(512,1,1) lds=144384
; @launch kernel=k2_kernel grid=(256,1,1) block=(320,1,1) lds=131072
; @launch kernel=k3_kernel grid=(64,1,1) block=(448,1,1) lds=150016
; @launch kernel=k4_kernel grid=(200,1,1) block=(256,1,1) lds=131072
; @launch kernel=k5_kernel grid=(224,1,1) block=(256,1,1) lds=131072
.amdgcn_target "amdgcn-amd-amdhsa--gfx950"
.text
.globl k1_kernel
.p2align 8
.type k1_kernel,@function
k1_kernel:
    s_cmp_ge_u32 s2, 192
    s_cbranch_scc1 K1_END
    s_load_dwordx4 s[4:7], s[0:1], 0
    s_load_dwordx4 s[8:11], s[0:1], 16
    s_load_dwordx2 s[12:13], s[0:1], 96
    v_lshrrev_b32 v1, 6, v0
    v_and_b32 v2, 63, v0
    v_readfirstlane_b32 s30, v1
    s_mov_b32 s33, 0x2AAAAAAB
    s_mul_hi_u32 s29, s2, s33
    s_mul_i32 s33, s29, 6
    s_sub_u32 s28, s2, s33
    s_lshr_b32 s31, s30, 1
    s_mul_i32 s32, s28, 3
    s_add_u32 s32, s32, s31
    v_lshlrev_b32 v6, 4, v2
    s_waitcnt lgkmcnt(0)
    s_mov_b32 s16, s4
    s_and_b32 s17, s5, 0xffff
    s_mov_b32 s18, 1835008
    s_mov_b32 s19, 0x00020000
    s_mov_b32 s24, s12
    s_and_b32 s25, s13, 0xffff
    s_mov_b32 s26, 67108864
    s_mov_b32 s27, 0x00020000
    s_lshl_b32 s38, s29, 3
    s_add_u32 s38, s38, s30
    s_mul_i32 s38, s38, 7168
    s_mul_i32 s39, s30, 7296
    s_add_u32 s39, s39, 86016
    s_mov_b64 s[50:51], exec
    s_mov_b32 exec_hi, 0x00ffffff
    s_mov_b32 m0, s39
    s_add_u32 s39, s39, 912
    buffer_load_dwordx4 v6, s[16:19], s38 offen lds
    s_add_u32 s38, s38, 896
    s_mov_b32 m0, s39
    s_add_u32 s39, s39, 912
    buffer_load_dwordx4 v6, s[16:19], s38 offen lds
    s_add_u32 s38, s38, 896
    s_mov_b32 m0, s39
    s_add_u32 s39, s39, 912
    buffer_load_dwordx4 v6, s[16:19], s38 offen lds
    s_add_u32 s38, s38, 896
    s_mov_b32 m0, s39
    s_add_u32 s39, s39, 912
    buffer_load_dwordx4 v6, s[16:19], s38 offen lds
    s_add_u32 s38, s38, 896
    s_mov_b32 m0, s39
    s_add_u32 s39, s39, 912
    buffer_load_dwordx4 v6, s[16:19], s38 offen lds
    s_add_u32 s38, s38, 896
    s_mov_b32 m0, s39
    s_add_u32 s39, s39, 912
    buffer_load_dwordx4 v6, s[16:19], s38 offen lds
    s_add_u32 s38, s38, 896
    s_mov_b32 m0, s39
    s_add_u32 s39, s39, 912
    buffer_load_dwordx4 v6, s[16:19], s38 offen lds
    s_add_u32 s38, s38, 896
    s_mov_b32 m0, s39
    s_add_u32 s39, s39, 912
    buffer_load_dwordx4 v6, s[16:19], s38 offen lds
    s_add_u32 s38, s38, 896
    s_mov_b64 exec, s[50:51]
    s_cmp_ge_u32 s30, 6
    s_cbranch_scc1 K1_NOW
    s_cmp_lt_u32 s32, 16
    s_cselect_b32 s20, s6, s8
    s_cselect_b32 s21, s7, s9
    s_mov_b32 s36, 896
    s_cselect_b32 s34, s36, 56
    s_mov_b32 s36, 401408
    s_cselect_b32 s22, s36, 25088
    s_mul_i32 s35, s32, 56
    s_cselect_b32 s35, s35, 0
    s_cmp_eq_u32 s32, 17
    s_cselect_b32 s20, s10, s20
    s_cselect_b32 s21, s11, s21
    s_and_b32 s21, s21, 0xffff
    s_mov_b32 s23, 0x00020000
    v_lshrrev_b32 v3, 2, v2
    v_mul_lo_u32 v4, v3, s34
    v_and_b32 v5, 3, v2
    v_lshl_add_u32 v4, v5, 4, v4
    v_add_u32 v4, s35, v4
    s_and_b32 s36, s30, 1
    s_mul_i32 s36, s36, 224
    s_mul_i32 s38, s36, s34
    s_mul_i32 s39, s31, 28672
    s_lshl_b32 s40, s36, 6
    s_add_u32 s39, s39, s40
    s_lshl_b32 s37, s34, 4
    s_mov_b32 m0, s39
    s_add_u32 s39, s39, 1024
    buffer_load_dwordx4 v4, s[20:23], s38 offen lds
    s_add_u32 s38, s38, s37
    s_mov_b32 m0, s39
    s_add_u32 s39, s39, 1024
    buffer_load_dwordx4 v4, s[20:23], s38 offen lds
    s_add_u32 s38, s38, s37
    s_mov_b32 m0, s39
    s_add_u32 s39, s39, 1024
    buffer_load_dwordx4 v4, s[20:23], s38 offen lds
    s_add_u32 s38, s38, s37
    s_mov_b32 m0, s39
    s_add_u32 s39, s39, 1024
    buffer_load_dwordx4 v4, s[20:23], s38 offen lds
    s_add_u32 s38, s38, s37
    s_mov_b32 m0, s39
    s_add_u32 s39, s39, 1024
    buffer_load_dwordx4 v4, s[20:23], s38 offen lds
    s_add_u32 s38, s38, s37
    s_mov_b32 m0, s39
    s_add_u32 s39, s39, 1024
    buffer_load_dwordx4 v4, s[20:23], s38 offen lds
    s_add_u32 s38, s38, s37
    s_mov_b32 m0, s39
    s_add_u32 s39, s39, 1024
    buffer_load_dwordx4 v4, s[20:23], s38 offen lds
    s_add_u32 s38, s38, s37
    s_mov_b32 m0, s39
    s_add_u32 s39, s39, 1024
    buffer_load_dwordx4 v4, s[20:23], s38 offen lds
    s_add_u32 s38, s38, s37
    s_mov_b32 m0, s39
    s_add_u32 s39, s39, 1024
    buffer_load_dwordx4 v4, s[20:23], s38 offen lds
    s_add_u32 s38, s38, s37
    s_mov_b32 m0, s39
    s_add_u32 s39, s39, 1024
    buffer_load_dwordx4 v4, s[20:23], s38 offen lds
    s_add_u32 s38, s38, s37
    s_mov_b32 m0, s39
    s_add_u32 s39, s39, 1024
    buffer_load_dwordx4 v4, s[20:23], s38 offen lds
    s_add_u32 s38, s38, s37
    s_mov_b32 m0, s39
    s_add_u32 s39, s39, 1024
    buffer_load_dwordx4 v4, s[20:23], s38 offen lds
    s_add_u32 s38, s38, s37
    s_mov_b32 m0, s39
    s_add_u32 s39, s39, 1024
    buffer_load_dwordx4 v4, s[20:23], s38 offen lds
    s_add_u32 s38, s38, s37
    s_mov_b32 m0, s39
    s_add_u32 s39, s39, 1024
    buffer_load_dwordx4 v4, s[20:23], s38 offen lds
    s_add_u32 s38, s38, s37
    s_waitcnt vmcnt(14)
    s_branch K1_LN
K1_NOW:
    s_waitcnt vmcnt(0)
K1_LN:
    v_lshrrev_b32 v7, 3, v2
    s_movk_i32 s43, 912
    v_mul_lo_u32 v7, v7, s43
    v_and_b32 v8, 7, v2
    v_lshl_add_u32 v7, v8, 4, v7
    s_mul_i32 s39, s30, 7296
    s_add_u32 s39, s39, 86016
    v_add_u32 v7, s39, v7
    ds_read_b128 v[64:67], v7 offset:0
    ds_read_b128 v[68:71], v7 offset:128
    ds_read_b128 v[72:75], v7 offset:256
    ds_read_b128 v[76:79], v7 offset:384
    ds_read_b128 v[80:83], v7 offset:512
    ds_read_b128 v[84:87], v7 offset:640
    ds_read_b128 v[88:91], v7 offset:768
    s_waitcnt lgkmcnt(0)
    v_lshlrev_b32 v128, 16, v64
    v_and_b32 v129, 0xffff0000, v64
    v_lshlrev_b32 v130, 16, v65
    v_and_b32 v131, 0xffff0000, v65
    v_lshlrev_b32 v132, 16, v66
    v_and_b32 v133, 0xffff0000, v66
    v_lshlrev_b32 v134, 16, v67
    v_and_b32 v135, 0xffff0000, v67
    v_lshlrev_b32 v136, 16, v68
    v_and_b32 v137, 0xffff0000, v68
    v_lshlrev_b32 v138, 16, v69
    v_and_b32 v139, 0xffff0000, v69
    v_lshlrev_b32 v140, 16, v70
    v_and_b32 v141, 0xffff0000, v70
    v_lshlrev_b32 v142, 16, v71
    v_and_b32 v143, 0xffff0000, v71
    v_lshlrev_b32 v144, 16, v72
    v_and_b32 v145, 0xffff0000, v72
    v_lshlrev_b32 v146, 16, v73
    v_and_b32 v147, 0xffff0000, v73
    v_lshlrev_b32 v148, 16, v74
    v_and_b32 v149, 0xffff0000, v74
    v_lshlrev_b32 v150, 16, v75
    v_and_b32 v151, 0xffff0000, v75
    v_lshlrev_b32 v152, 16, v76
    v_and_b32 v153, 0xffff0000, v76
    v_lshlrev_b32 v154, 16, v77
    v_and_b32 v155, 0xffff0000, v77
    v_lshlrev_b32 v156, 16, v78
    v_and_b32 v157, 0xffff0000, v78
    v_lshlrev_b32 v158, 16, v79
    v_and_b32 v159, 0xffff0000, v79
    v_lshlrev_b32 v160, 16, v80
    v_and_b32 v161, 0xffff0000, v80
    v_lshlrev_b32 v162, 16, v81
    v_and_b32 v163, 0xffff0000, v81
    v_lshlrev_b32 v164, 16, v82
    v_and_b32 v165, 0xffff0000, v82
    v_lshlrev_b32 v166, 16, v83
    v_and_b32 v167, 0xffff0000, v83
    v_lshlrev_b32 v168, 16, v84
    v_and_b32 v169, 0xffff0000, v84
    v_lshlrev_b32 v170, 16, v85
    v_and_b32 v171, 0xffff0000, v85
    v_lshlrev_b32 v172, 16, v86
    v_and_b32 v173, 0xffff0000, v86
    v_lshlrev_b32 v174, 16, v87
    v_and_b32 v175, 0xffff0000, v87
    v_lshlrev_b32 v176, 16, v88
    v_and_b32 v177, 0xffff0000, v88
    v_lshlrev_b32 v178, 16, v89
    v_and_b32 v179, 0xffff0000, v89
    v_lshlrev_b32 v180, 16, v90
    v_and_b32 v181, 0xffff0000, v90
    v_lshlrev_b32 v182, 16, v91
    v_and_b32 v183, 0xffff0000, v91
    v_pk_add_f32 v[52:53], v[128:129], v[130:131]
    v_pk_mul_f32 v[54:55], v[128:129], v[128:129]
    v_pk_fma_f32 v[54:55], v[130:131], v[130:131], v[54:55]
    v_pk_add_f32 v[52:53], v[52:53], v[132:133]
    v_pk_fma_f32 v[54:55], v[132:133], v[132:133], v[54:55]
    v_pk_add_f32 v[52:53], v[52:53], v[134:135]
    v_pk_fma_f32 v[54:55], v[134:135], v[134:135], v[54:55]
    v_pk_add_f32 v[52:53], v[52:53], v[136:137]
    v_pk_fma_f32 v[54:55], v[136:137], v[136:137], v[54:55]
    v_pk_add_f32 v[52:53], v[52:53], v[138:139]
    v_pk_fma_f32 v[54:55], v[138:139], v[138:139], v[54:55]
    v_pk_add_f32 v[52:53], v[52:53], v[140:141]
    v_pk_fma_f32 v[54:55], v[140:141], v[140:141], v[54:55]
    v_pk_add_f32 v[52:53], v[52:53], v[142:143]
    v_pk_fma_f32 v[54:55], v[142:143], v[142:143], v[54:55]
    v_pk_add_f32 v[52:53], v[52:53], v[144:145]
    v_pk_fma_f32 v[54:55], v[144:145], v[144:145], v[54:55]
    v_pk_add_f32 v[52:53], v[52:53], v[146:147]
    v_pk_fma_f32 v[54:55], v[146:147], v[146:147], v[54:55]
    v_pk_add_f32 v[52:53], v[52:53], v[148:149]
    v_pk_fma_f32 v[54:55], v[148:149], v[148:149], v[54:55]
    v_pk_add_f32 v[52:53], v[52:53], v[150:151]
    v_pk_fma_f32 v[54:55], v[150:151], v[150:151], v[54:55]
    v_pk_add_f32 v[52:53], v[52:53], v[152:153]
    v_pk_fma_f32 v[54:55], v[152:153], v[152:153], v[54:55]
    v_pk_add_f32 v[52:53], v[52:53], v[154:155]
    v_pk_fma_f32 v[54:55], v[154:155], v[154:155], v[54:55]
    v_pk_add_f32 v[52:53], v[52:53], v[156:157]
    v_pk_fma_f32 v[54:55], v[156:157], v[156:157], v[54:55]
    v_pk_add_f32 v[52:53], v[52:53], v[158:159]
    v_pk_fma_f32 v[54:55], v[158:159], v[158:159], v[54:55]
    v_pk_add_f32 v[52:53], v[52:53], v[160:161]
    v_pk_fma_f32 v[54:55], v[160:161], v[160:161], v[54:55]
    v_pk_add_f32 v[52:53], v[52:53], v[162:163]
    v_pk_fma_f32 v[54:55], v[162:163], v[162:163], v[54:55]
    v_pk_add_f32 v[52:53], v[52:53], v[164:165]
    v_pk_fma_f32 v[54:55], v[164:165], v[164:165], v[54:55]
    v_pk_add_f32 v[52:53], v[52:53], v[166:167]
    v_pk_fma_f32 v[54:55], v[166:167], v[166:167], v[54:55]
    v_pk_add_f32 v[52:53], v[52:53], v[168:169]
    v_pk_fma_f32 v[54:55], v[168:169], v[168:169], v[54:55]
    v_pk_add_f32 v[52:53], v[52:53], v[170:171]
    v_pk_fma_f32 v[54:55], v[170:171], v[170:171], v[54:55]
    v_pk_add_f32 v[52:53], v[52:53], v[172:173]
    v_pk_fma_f32 v[54:55], v[172:173], v[172:173], v[54:55]
    v_pk_add_f32 v[52:53], v[52:53], v[174:175]
    v_pk_fma_f32 v[54:55], v[174:175], v[174:175], v[54:55]
    v_pk_add_f32 v[52:53], v[52:53], v[176:177]
    v_pk_fma_f32 v[54:55], v[176:177], v[176:177], v[54:55]
    v_pk_add_f32 v[52:53], v[52:53], v[178:179]
    v_pk_fma_f32 v[54:55], v[178:179], v[178:179], v[54:55]
    v_pk_add_f32 v[52:53], v[52:53], v[180:181]
    v_pk_fma_f32 v[54:55], v[180:181], v[180:181], v[54:55]
    v_pk_add_f32 v[52:53], v[52:53], v[182:183]
    v_pk_fma_f32 v[54:55], v[182:183], v[182:183], v[54:55]
    v_add_f32 v52, v52, v53
    v_add_f32 v54, v54, v55
    s_nop 1
    v_add_f32_dpp v52, v52, v52 quad_perm:[1,0,3,2] row_mask:0xf bank_mask:0xf
    v_add_f32_dpp v54, v54, v54 quad_perm:[1,0,3,2] row_mask:0xf bank_mask:0xf
    s_nop 1
    v_add_f32_dpp v52, v52, v52 quad_perm:[2,3,0,1] row_mask:0xf bank_mask:0xf
    v_add_f32_dpp v54, v54, v54 quad_perm:[2,3,0,1] row_mask:0xf bank_mask:0xf
    s_nop 1
    v_add_f32_dpp v52, v52, v52 row_half_mirror row_mask:0xf bank_mask:0xf
    v_add_f32_dpp v54, v54, v54 row_half_mirror row_mask:0xf bank_mask:0xf
    v_mul_f32 v52, 0x3b124925, v52
    v_mul_f32 v54, 0x3b124925, v54
    v_fma_f32 v54, -v52, v52, v54
    v_add_f32 v54, 0x3727c5ac, v54
    v_rsq_f32 v54, v54
    s_nop 0
    v_mul_f32 v52, v52, v54
    v_sub_f32 v52, 0, v52
    v_mov_b32 v53, v52
    v_mov_b32 v55, v54
    v_pk_fma_f32 v[128:129], v[128:129], v[54:55], v[52:53]
    v_pk_fma_f32 v[130:131], v[130:131], v[54:55], v[52:53]
    v_pk_fma_f32 v[132:133], v[132:133], v[54:55], v[52:53]
    v_pk_fma_f32 v[134:135], v[134:135], v[54:55], v[52:53]
    v_pk_fma_f32 v[136:137], v[136:137], v[54:55], v[52:53]
    v_pk_fma_f32 v[138:139], v[138:139], v[54:55], v[52:53]
    v_pk_fma_f32 v[140:141], v[140:141], v[54:55], v[52:53]
    v_pk_fma_f32 v[142:143], v[142:143], v[54:55], v[52:53]
    v_pk_fma_f32 v[144:145], v[144:145], v[54:55], v[52:53]
    v_pk_fma_f32 v[146:147], v[146:147], v[54:55], v[52:53]
    v_pk_fma_f32 v[148:149], v[148:149], v[54:55], v[52:53]
    v_pk_fma_f32 v[150:151], v[150:151], v[54:55], v[52:53]
    v_pk_fma_f32 v[152:153], v[152:153], v[54:55], v[52:53]
    v_pk_fma_f32 v[154:155], v[154:155], v[54:55], v[52:53]
    v_pk_fma_f32 v[156:157], v[156:157], v[54:55], v[52:53]
    v_pk_fma_f32 v[158:159], v[158:159], v[54:55], v[52:53]
    v_pk_fma_f32 v[160:161], v[160:161], v[54:55], v[52:53]
    v_pk_fma_f32 v[162:163], v[162:163], v[54:55], v[52:53]
    v_pk_fma_f32 v[164:165], v[164:165], v[54:55], v[52:53]
    v_pk_fma_f32 v[166:167], v[166:167], v[54:55], v[52:53]
    v_pk_fma_f32 v[168:169], v[168:169], v[54:55], v[52:53]
    v_pk_fma_f32 v[170:171], v[170:171], v[54:55], v[52:53]
    v_pk_fma_f32 v[172:173], v[172:173], v[54:55], v[52:53]
    v_pk_fma_f32 v[174:175], v[174:175], v[54:55], v[52:53]
    v_pk_fma_f32 v[176:177], v[176:177], v[54:55], v[52:53]
    v_pk_fma_f32 v[178:179], v[178:179], v[54:55], v[52:53]
    v_pk_fma_f32 v[180:181], v[180:181], v[54:55], v[52:53]
    v_pk_fma_f32 v[182:183], v[182:183], v[54:55], v[52:53]
    v_cvt_pk_bf16_f32 v64, v128, v129
    v_cvt_pk_bf16_f32 v65, v130, v131
    v_cvt_pk_bf16_f32 v66, v132, v133
    v_cvt_pk_bf16_f32 v67, v134, v135
    v_cvt_pk_bf16_f32 v68, v136, v137
    v_cvt_pk_bf16_f32 v69, v138, v139
    v_cvt_pk_bf16_f32 v70, v140, v141
    v_cvt_pk_bf16_f32 v71, v142, v143
    v_cvt_pk_bf16_f32 v72, v144, v145
    v_cvt_pk_bf16_f32 v73, v146, v147
    v_cvt_pk_bf16_f32 v74, v148, v149
    v_cvt_pk_bf16_f32 v75, v150, v151
    v_cvt_pk_bf16_f32 v76, v152, v153
    v_cvt_pk_bf16_f32 v77, v154, v155
    v_cvt_pk_bf16_f32 v78, v156, v157
    v_cvt_pk_bf16_f32 v79, v158, v159
    v_cvt_pk_bf16_f32 v80, v160, v161
    v_cvt_pk_bf16_f32 v81, v162, v163
    v_cvt_pk_bf16_f32 v82, v164, v165
    v_cvt_pk_bf16_f32 v83, v166, v167
    v_cvt_pk_bf16_f32 v84, v168, v169
    v_cvt_pk_bf16_f32 v85, v170, v171
    v_cvt_pk_bf16_f32 v86, v172, v173
    v_cvt_pk_bf16_f32 v87, v174, v175
    v_cvt_pk_bf16_f32 v88, v176, v177
    v_cvt_pk_bf16_f32 v89, v178, v179
    v_cvt_pk_bf16_f32 v90, v180, v181
    v_cvt_pk_bf16_f32 v91, v182, v183
    ds_write_b128 v7, v[64:67] offset:0
    ds_write_b128 v7, v[68:71] offset:128
    ds_write_b128 v7, v[72:75] offset:256
    ds_write_b128 v7, v[76:79] offset:384
    ds_write_b128 v7, v[80:83] offset:512
    ds_write_b128 v7, v[84:87] offset:640
    ds_write_b128 v7, v[88:91] offset:768
    s_waitcnt lgkmcnt(0) vmcnt(0)
    s_barrier
    s_cmp_ge_u32 s30, 6
    s_cbranch_scc1 K1_END
    s_cmp_ge_u32 s30, 3
    s_cselect_b32 s39, 1, 0
    s_mul_i32 s40, s39, 3
    s_sub_u32 s40, s30, s40
    s_lshl_b32 s41, s29, 1
    s_add_u32 s41, s41, s39
    v_and_b32 v8, 31, v2
    s_lshl_b32 s42, s39, 5
    v_add_u32 v8, s42, v8
    v_mul_lo_u32 v8, v8, s43
    v_lshrrev_b32 v9, 5, v2
    v_lshl_add_u32 v8, v9, 4, v8
    v_add_u32 v8, 86016, v8
    v_lshrrev_b32 v10, 4, v2
    v_and_b32 v11, 15, v2
    v_lshrrev_b32 v12, 1, v10
    v_lshlrev_b32 v12, 3, v12
    v_lshrrev_b32 v13, 2, v11
    v_add_u32 v12, v12, v13
    v_lshlrev_b32 v12, 6, v12
    v_and_b32 v13, 1, v10
    v_lshl_add_u32 v12, v13, 5, v12
    v_and_b32 v13, 3, v11
    v_lshl_add_u32 v12, v13, 3, v12
    s_mul_i32 s44, s40, 28672
    v_add_u32 v12, s44, v12
    s_mul_i32 s45, s28, 3
    s_add_u32 s45, s45, s40
    s_cmp_eq_u32 s45, 17
    s_cbranch_scc1 K1_V
    ds_read_b128 v[128:131], v8 offset:0
    ds_read_b64_tr_b16 v[16:17], v12 offset:0
    ds_read_b64_tr_b16 v[18:19], v12 offset:256
    ds_read_b128 v[132:135], v8 offset:32
    ds_read_b64_tr_b16 v[20:21], v12 offset:1024
    ds_read_b64_tr_b16 v[22:23], v12 offset:1280
    ds_read_b128 v[136:139], v8 offset:64
    ds_read_b64_tr_b16 v[24:25], v12 offset:2048
    ds_read_b64_tr_b16 v[26:27], v12 offset:2304
    ds_read_b128 v[140:143], v8 offset:96
    ds_read_b64_tr_b16 v[28:29], v12 offset:3072
    ds_read_b64_tr_b16 v[30:31], v12 offset:3328
    ds_read_b128 v[144:147], v8 offset:128
    ds_read_b64_tr_b16 v[32:33], v12 offset:4096
    ds_read_b64_tr_b16 v[34:35], v12 offset:4352
    s_waitcnt lgkmcnt(12)
    v_mfma_f32_32x32x16_bf16 v[240:255], v[16:19], v[128:131], 0
    ds_read_b128 v[148:151], v8 offset:160
    ds_read_b64_tr_b16 v[36:37], v12 offset:5120
    ds_read_b64_tr_b16 v[38:39], v12 offset:5376
    s_waitcnt lgkmcnt(12)
    v_mfma_f32_32x32x16_bf16 v[240:255], v[20:23], v[132:135], v[240:255]
    ds_read_b128 v[152:155], v8 offset:192
    ds_read_b64_tr_b16 v[40:41], v12 offset:6144
    ds_read_b64_tr_b16 v[42:43], v12 offset:6400
    s_waitcnt lgkmcnt(12)
    v_mfma_f32_32x32x16_bf16 v[240:255], v[24:27], v[136:139], v[240:255]
    ds_read_b128 v[156:159], v8 offset:224
    ds_read_b64_tr_b16 v[44:45], v12 offset:7168
    ds_read_b64_tr_b16 v[46:47], v12 offset:7424
    s_waitcnt lgkmcnt(12)
    v_mfma_f32_32x32x16_bf16 v[240:255], v[28:31], v[140:143], v[240:255]
    ds_read_b128 v[160:163], v8 offset:256
    ds_read_b64_tr_b16 v[48:49], v12 offset:8192
    ds_read_b64_tr_b16 v[50:51], v12 offset:8448
    s_waitcnt lgkmcnt(12)
    v_mfma_f32_32x32x16_bf16 v[240:255], v[32:35], v[144:147], v[240:255]
    ds_read_b128 v[164:167], v8 offset:288
    ds_read_b64_tr_b16 v[52:53], v12 offset:9216
    ds_read_b64_tr_b16 v[54:55], v12 offset:9472
    s_waitcnt lgkmcnt(12)
    v_mfma_f32_32x32x16_bf16 v[240:255], v[36:39], v[148:151], v[240:255]
    ds_read_b128 v[168:171], v8 offset:320
    ds_read_b64_tr_b16 v[56:57], v12 offset:10240
    ds_read_b64_tr_b16 v[58:59], v12 offset:10496
    s_waitcnt lgkmcnt(12)
    v_mfma_f32_32x32x16_bf16 v[240:255], v[40:43], v[152:155], v[240:255]
    ds_read_b128 v[172:175], v8 offset:352
    ds_read_b64_tr_b16 v[60:61], v12 offset:11264
    ds_read_b64_tr_b16 v[62:63], v12 offset:11520
    s_waitcnt lgkmcnt(12)
    v_mfma_f32_32x32x16_bf16 v[240:255], v[44:47], v[156:159], v[240:255]
    ds_read_b128 v[176:179], v8 offset:384
    ds_read_b64_tr_b16 v[64:65], v12 offset:12288
    ds_read_b64_tr_b16 v[66:67], v12 offset:12544
    s_waitcnt lgkmcnt(12)
    v_mfma_f32_32x32x16_bf16 v[240:255], v[48:51], v[160:163], v[240:255]
    ds_read_b128 v[180:183], v8 offset:416
    ds_read_b64_tr_b16 v[68:69], v12 offset:13312
    ds_read_b64_tr_b16 v[70:71], v12 offset:13568
    s_waitcnt lgkmcnt(12)
    v_mfma_f32_32x32x16_bf16 v[240:255], v[52:55], v[164:167], v[240:255]
    ds_read_b128 v[184:187], v8 offset:448
    ds_read_b64_tr_b16 v[72:73], v12 offset:14336
    ds_read_b64_tr_b16 v[74:75], v12 offset:14592
    s_waitcnt lgkmcnt(12)
    v_mfma_f32_32x32x16_bf16 v[240:255], v[56:59], v[168:171], v[240:255]
    ds_read_b128 v[188:191], v8 offset:480
    ds_read_b64_tr_b16 v[76:77], v12 offset:15360
    ds_read_b64_tr_b16 v[78:79], v12 offset:15616
    s_waitcnt lgkmcnt(12)
    v_mfma_f32_32x32x16_bf16 v[240:255], v[60:63], v[172:175], v[240:255]
    ds_read_b128 v[192:195], v8 offset:512
    ds_read_b64_tr_b16 v[80:81], v12 offset:16384
    ds_read_b64_tr_b16 v[82:83], v12 offset:16640
    s_waitcnt lgkmcnt(12)
    v_mfma_f32_32x32x16_bf16 v[240:255], v[64:67], v[176:179], v[240:255]
    ds_read_b128 v[196:199], v8 offset:544
    ds_read_b64_tr_b16 v[84:85], v12 offset:17408
    ds_read_b64_tr_b16 v[86:87], v12 offset:17664
    s_waitcnt lgkmcnt(12)
    v_mfma_f32_32x32x16_bf16 v[240:255], v[68:71], v[180:183], v[240:255]
    ds_read_b128 v[200:203], v8 offset:576
    ds_read_b64_tr_b16 v[88:89], v12 offset:18432
    ds_read_b64_tr_b16 v[90:91], v12 offset:18688
    s_waitcnt lgkmcnt(12)
    v_mfma_f32_32x32x16_bf16 v[240:255], v[72:75], v[184:187], v[240:255]
    ds_read_b128 v[204:207], v8 offset:608
    ds_read_b64_tr_b16 v[92:93], v12 offset:19456
    ds_read_b64_tr_b16 v[94:95], v12 offset:19712
    s_waitcnt lgkmcnt(12)
    v_mfma_f32_32x32x16_bf16 v[240:255], v[76:79], v[188:191], v[240:255]
    ds_read_b128 v[208:211], v8 offset:640
    ds_read_b64_tr_b16 v[96:97], v12 offset:20480
    ds_read_b64_tr_b16 v[98:99], v12 offset:20736
    s_waitcnt lgkmcnt(12)
    v_mfma_f32_32x32x16_bf16 v[240:255], v[80:83], v[192:195], v[240:255]
    ds_read_b128 v[212:215], v8 offset:672
    ds_read_b64_tr_b16 v[100:101], v12 offset:21504
    ds_read_b64_tr_b16 v[102:103], v12 offset:21760
    s_waitcnt lgkmcnt(12)
    v_mfma_f32_32x32x16_bf16 v[240:255], v[84:87], v[196:199], v[240:255]
    ds_read_b128 v[216:219], v8 offset:704
    ds_read_b64_tr_b16 v[104:105], v12 offset:22528
    ds_read_b64_tr_b16 v[106:107], v12 offset:22784
    s_waitcnt lgkmcnt(12)
    v_mfma_f32_32x32x16_bf16 v[240:255], v[88:91], v[200:203], v[240:255]
    ds_read_b128 v[220:223], v8 offset:736
    ds_read_b64_tr_b16 v[108:109], v12 offset:23552
    ds_read_b64_tr_b16 v[110:111], v12 offset:23808
    s_waitcnt lgkmcnt(12)
    v_mfma_f32_32x32x16_bf16 v[240:255], v[92:95], v[204:207], v[240:255]
    ds_read_b128 v[224:227], v8 offset:768
    ds_read_b64_tr_b16 v[112:113], v12 offset:24576
    ds_read_b64_tr_b16 v[114:115], v12 offset:24832
    s_waitcnt lgkmcnt(12)
    v_mfma_f32_32x32x16_bf16 v[240:255], v[96:99], v[208:211], v[240:255]
    ds_read_b128 v[228:231], v8 offset:800
    ds_read_b64_tr_b16 v[116:117], v12 offset:25600
    ds_read_b64_tr_b16 v[118:119], v12 offset:25856
    s_waitcnt lgkmcnt(12)
    v_mfma_f32_32x32x16_bf16 v[240:255], v[100:103], v[212:215], v[240:255]
    ds_read_b128 v[232:235], v8 offset:832
    ds_read_b64_tr_b16 v[120:121], v12 offset:26624
    ds_read_b64_tr_b16 v[122:123], v12 offset:26880
    s_waitcnt lgkmcnt(12)
    v_mfma_f32_32x32x16_bf16 v[240:255], v[104:107], v[216:219], v[240:255]
    ds_read_b128 v[236:239], v8 offset:864
    ds_read_b64_tr_b16 v[124:125], v12 offset:27648
    ds_read_b64_tr_b16 v[126:127], v12 offset:27904
    s_waitcnt lgkmcnt(12)
    v_mfma_f32_32x32x16_bf16 v[240:255], v[108:111], v[220:223], v[240:255]
    s_waitcnt lgkmcnt(9)
    v_mfma_f32_32x32x16_bf16 v[240:255], v[112:115], v[224:227], v[240:255]
    s_waitcnt lgkmcnt(6)
    v_mfma_f32_32x32x16_bf16 v[240:255], v[116:119], v[228:231], v[240:255]
    s_waitcnt lgkmcnt(3)
    v_mfma_f32_32x32x16_bf16 v[240:255], v[120:123], v[232:235], v[240:255]
    s_waitcnt lgkmcnt(0)
    v_mfma_f32_32x32x16_bf16 v[240:255], v[124:127], v[236:239], v[240:255]
    s_nop 7
    s_nop 7
    s_cmp_lt_u32 s45, 16
    s_cselect_b32 s46, 0x3e8b97f6, 1.0
    v_cmp_eq_u32 vcc, 1, v9
    v_mul_f32 v240, s46, v240
    v_mul_f32 v241, s46, v241
    v_mul_f32 v242, s46, v242
    v_mul_f32 v243, s46, v243
    v_mul_f32 v244, s46, v244
    v_mul_f32 v245, s46, v245
    v_mul_f32 v246, s46, v246
    v_mul_f32 v247, s46, v247
    v_mul_f32 v248, s46, v248
    v_mul_f32 v249, s46, v249
    v_mul_f32 v250, s46, v250
    v_mul_f32 v251, s46, v251
    v_mul_f32 v252, s46, v252
    v_mul_f32 v253, s46, v253
    v_mul_f32 v254, s46, v254
    v_mul_f32 v255, s46, v255
    v_mov_b32 v3, 0
    v_cndmask_b32 v252, v252, v3, vcc
    v_cndmask_b32 v253, v253, v3, vcc
    v_cndmask_b32 v254, v254, v3, vcc
    v_cndmask_b32 v255, v255, v3, vcc
    v_cvt_pk_bf16_f32 v64, v240, v241
    v_cvt_pk_bf16_f32 v65, v242, v243
    v_cvt_pk_bf16_f32 v66, v244, v245
    v_cvt_pk_bf16_f32 v67, v246, v247
    v_cvt_pk_bf16_f32 v68, v248, v249
    v_cvt_pk_bf16_f32 v69, v250, v251
    v_cvt_pk_bf16_f32 v70, v252, v253
    v_cvt_pk_bf16_f32 v71, v254, v255
    s_lshl_b32 s47, s45, 6
    s_add_u32 s47, s47, s41
    s_lshl_b32 s47, s47, 11
    s_add_u32 s47, s47, 0
    s_lshl_b32 s48, s41, 12
    s_add_u32 s48, s48, 2097152
    s_cmp_lt_u32 s45, 16
    s_cselect_b32 s47, s47, s48
    buffer_store_dwordx4 v[64:67], v6, s[24:27], s47 offen
    buffer_store_dwordx4 v[68:71], v6, s[24:27], s47 offen offset:1024
    s_cmp_eq_u32 s45, 16
    s_cbranch_scc0 K1_NOKN
    v_pk_mul_f32 v[4:5], v[240:241], v[240:241]
    v_pk_fma_f32 v[4:5], v[242:243], v[242:243], v[4:5]
    v_pk_fma_f32 v[4:5], v[244:245], v[244:245], v[4:5]
    v_pk_fma_f32 v[4:5], v[246:247], v[246:247], v[4:5]
    v_pk_fma_f32 v[4:5], v[248:249], v[248:249], v[4:5]
    v_pk_fma_f32 v[4:5], v[250:251], v[250:251], v[4:5]
    v_pk_fma_f32 v[4:5], v[252:253], v[252:253], v[4:5]
    v_pk_fma_f32 v[4:5], v[254:255], v[254:255], v[4:5]
    v_add_f32 v4, v4, v5
    v_mov_b32 v5, v4
    s_nop 1
    v_permlane32_swap_b32 v4, v5
    v_add_f32 v4, v4, v5
    s_nop 1
    v_max_f32_dpp v4, v4, v4 row_shr:1 row_mask:0xf bank_mask:0xf
    s_nop 1
    v_max_f32_dpp v4, v4, v4 row_shr:2 row_mask:0xf bank_mask:0xf
    s_nop 1
    v_max_f32_dpp v4, v4, v4 row_shr:4 row_mask:0xf bank_mask:0xf
    s_nop 1
    v_max_f32_dpp v4, v4, v4 row_shr:8 row_mask:0xf bank_mask:0xf
    s_nop 1
    v_max_f32_dpp v4, v4, v4 row_bcast:15 row_mask:0xa bank_mask:0xf
    s_nop 1
    v_max_f32_dpp v4, v4, v4 row_bcast:31 row_mask:0xc bank_mask:0xf
    s_nop 1
    v_readlane_b32 s49, v4, 63
    s_lshl_b32 s48, s41, 2
    s_add_u32 s48, s48, 10420224
    v_mov_b32 v5, 0
    v_mov_b32 v4, s49
    buffer_store_dword v4, v5, s[24:27], s48 offen
K1_NOKN:
    s_endpgm
K1_V:
    ds_read_b128 v[128:131], v8 offset:0
    ds_read_b64_tr_b16 v[16:17], v12 offset:0
    ds_read_b64_tr_b16 v[18:19], v12 offset:256
    ds_read_b128 v[132:135], v8 offset:32
    ds_read_b64_tr_b16 v[20:21], v12 offset:1024
    ds_read_b64_tr_b16 v[22:23], v12 offset:1280
    ds_read_b128 v[136:139], v8 offset:64
    ds_read_b64_tr_b16 v[24:25], v12 offset:2048
    ds_read_b64_tr_b16 v[26:27], v12 offset:2304
    ds_read_b128 v[140:143], v8 offset:96
    ds_read_b64_tr_b16 v[28:29], v12 offset:3072
    ds_read_b64_tr_b16 v[30:31], v12 offset:3328
    ds_read_b128 v[144:147], v8 offset:128
    ds_read_b64_tr_b16 v[32:33], v12 offset:4096
    ds_read_b64_tr_b16 v[34:35], v12 offset:4352
    s_waitcnt lgkmcnt(12)
    v_mfma_f32_32x32x16_bf16 v[240:255], v[128:131], v[16:19], 0
    ds_read_b128 v[148:151], v8 offset:160
    ds_read_b64_tr_b16 v[36:37], v12 offset:5120
    ds_read_b64_tr_b16 v[38:39], v12 offset:5376
    s_waitcnt lgkmcnt(12)
    v_mfma_f32_32x32x16_bf16 v[240:255], v[132:135], v[20:23], v[240:255]
    ds_read_b128 v[152:155], v8 offset:192
    ds_read_b64_tr_b16 v[40:41], v12 offset:6144
    ds_read_b64_tr_b16 v[42:43], v12 offset:6400
    s_waitcnt lgkmcnt(12)
    v_mfma_f32_32x32x16_bf16 v[240:255], v[136:139], v[24:27], v[240:255]
    ds_read_b128 v[156:159], v8 offset:224
    ds_read_b64_tr_b16 v[44:45], v12 offset:7168
    ds_read_b64_tr_b16 v[46:47], v12 offset:7424
    s_waitcnt lgkmcnt(12)
    v_mfma_f32_32x32x16_bf16 v[240:255], v[140:143], v[28:31], v[240:255]
    ds_read_b128 v[160:163], v8 offset:256
    ds_read_b64_tr_b16 v[48:49], v12 offset:8192
    ds_read_b64_tr_b16 v[50:51], v12 offset:8448
    s_waitcnt lgkmcnt(12)
    v_mfma_f32_32x32x16_bf16 v[240:255], v[144:147], v[32:35], v[240:255]
    ds_read_b128 v[164:167], v8 offset:288
    ds_read_b64_tr_b16 v[52:53], v12 offset:9216
    ds_read_b64_tr_b16 v[54:55], v12 offset:9472
    s_waitcnt lgkmcnt(12)
    v_mfma_f32_32x32x16_bf16 v[240:255], v[148:151], v[36:39], v[240:255]
    ds_read_b128 v[168:171], v8 offset:320
    ds_read_b64_tr_b16 v[56:57], v12 offset:10240
    ds_read_b64_tr_b16 v[58:59], v12 offset:10496
    s_waitcnt lgkmcnt(12)
    v_mfma_f32_32x32x16_bf16 v[240:255], v[152:155], v[40:43], v[240:255]
    ds_read_b128 v[172:175], v8 offset:352
    ds_read_b64_tr_b16 v[60:61], v12 offset:11264
    ds_read_b64_tr_b16 v[62:63], v12 offset:11520
    s_waitcnt lgkmcnt(12)
    v_mfma_f32_32x32x16_bf16 v[240:255], v[156:159], v[44:47], v[240:255]
    ds_read_b128 v[176:179], v8 offset:384
    ds_read_b64_tr_b16 v[64:65], v12 offset:12288
    ds_read_b64_tr_b16 v[66:67], v12 offset:12544
    s_waitcnt lgkmcnt(12)
    v_mfma_f32_32x32x16_bf16 v[240:255], v[160:163], v[48:51], v[240:255]
    ds_read_b128 v[180:183], v8 offset:416
    ds_read_b64_tr_b16 v[68:69], v12 offset:13312
    ds_read_b64_tr_b16 v[70:71], v12 offset:13568
    s_waitcnt lgkmcnt(12)
    v_mfma_f32_32x32x16_bf16 v[240:255], v[164:167], v[52:55], v[240:255]
    ds_read_b128 v[184:187], v8 offset:448
    ds_read_b64_tr_b16 v[72:73], v12 offset:14336
    ds_read_b64_tr_b16 v[74:75], v12 offset:14592
    s_waitcnt lgkmcnt(12)
    v_mfma_f32_32x32x16_bf16 v[240:255], v[168:171], v[56:59], v[240:255]
    ds_read_b128 v[188:191], v8 offset:480
    ds_read_b64_tr_b16 v[76:77], v12 offset:15360
    ds_read_b64_tr_b16 v[78:79], v12 offset:15616
    s_waitcnt lgkmcnt(12)
    v_mfma_f32_32x32x16_bf16 v[240:255], v[172:175], v[60:63], v[240:255]
    ds_read_b128 v[192:195], v8 offset:512
    ds_read_b64_tr_b16 v[80:81], v12 offset:16384
    ds_read_b64_tr_b16 v[82:83], v12 offset:16640
    s_waitcnt lgkmcnt(12)
    v_mfma_f32_32x32x16_bf16 v[240:255], v[176:179], v[64:67], v[240:255]
    ds_read_b128 v[196:199], v8 offset:544
    ds_read_b64_tr_b16 v[84:85], v12 offset:17408
    ds_read_b64_tr_b16 v[86:87], v12 offset:17664
    s_waitcnt lgkmcnt(12)
    v_mfma_f32_32x32x16_bf16 v[240:255], v[180:183], v[68:71], v[240:255]
    ds_read_b128 v[200:203], v8 offset:576
    ds_read_b64_tr_b16 v[88:89], v12 offset:18432
    ds_read_b64_tr_b16 v[90:91], v12 offset:18688
    s_waitcnt lgkmcnt(12)
    v_mfma_f32_32x32x16_bf16 v[240:255], v[184:187], v[72:75], v[240:255]
    ds_read_b128 v[204:207], v8 offset:608
    ds_read_b64_tr_b16 v[92:93], v12 offset:19456
    ds_read_b64_tr_b16 v[94:95], v12 offset:19712
    s_waitcnt lgkmcnt(12)
    v_mfma_f32_32x32x16_bf16 v[240:255], v[188:191], v[76:79], v[240:255]
    ds_read_b128 v[208:211], v8 offset:640
    ds_read_b64_tr_b16 v[96:97], v12 offset:20480
    ds_read_b64_tr_b16 v[98:99], v12 offset:20736
    s_waitcnt lgkmcnt(12)
    v_mfma_f32_32x32x16_bf16 v[240:255], v[192:195], v[80:83], v[240:255]
    ds_read_b128 v[212:215], v8 offset:672
    ds_read_b64_tr_b16 v[100:101], v12 offset:21504
    ds_read_b64_tr_b16 v[102:103], v12 offset:21760
    s_waitcnt lgkmcnt(12)
    v_mfma_f32_32x32x16_bf16 v[240:255], v[196:199], v[84:87], v[240:255]
    ds_read_b128 v[216:219], v8 offset:704
    ds_read_b64_tr_b16 v[104:105], v12 offset:22528
    ds_read_b64_tr_b16 v[106:107], v12 offset:22784
    s_waitcnt lgkmcnt(12)
    v_mfma_f32_32x32x16_bf16 v[240:255], v[200:203], v[88:91], v[240:255]
    ds_read_b128 v[220:223], v8 offset:736
    ds_read_b64_tr_b16 v[108:109], v12 offset:23552
    ds_read_b64_tr_b16 v[110:111], v12 offset:23808
    s_waitcnt lgkmcnt(12)
    v_mfma_f32_32x32x16_bf16 v[240:255], v[204:207], v[92:95], v[240:255]
    ds_read_b128 v[224:227], v8 offset:768
    ds_read_b64_tr_b16 v[112:113], v12 offset:24576
    ds_read_b64_tr_b16 v[114:115], v12 offset:24832
    s_waitcnt lgkmcnt(12)
    v_mfma_f32_32x32x16_bf16 v[240:255], v[208:211], v[96:99], v[240:255]
    ds_read_b128 v[228:231], v8 offset:800
    ds_read_b64_tr_b16 v[116:117], v12 offset:25600
    ds_read_b64_tr_b16 v[118:119], v12 offset:25856
    s_waitcnt lgkmcnt(12)
    v_mfma_f32_32x32x16_bf16 v[240:255], v[212:215], v[100:103], v[240:255]
    ds_read_b128 v[232:235], v8 offset:832
    ds_read_b64_tr_b16 v[120:121], v12 offset:26624
    ds_read_b64_tr_b16 v[122:123], v12 offset:26880
    s_waitcnt lgkmcnt(12)
    v_mfma_f32_32x32x16_bf16 v[240:255], v[216:219], v[104:107], v[240:255]
    ds_read_b128 v[236:239], v8 offset:864
    ds_read_b64_tr_b16 v[124:125], v12 offset:27648
    ds_read_b64_tr_b16 v[126:127], v12 offset:27904
    s_waitcnt lgkmcnt(12)
    v_mfma_f32_32x32x16_bf16 v[240:255], v[220:223], v[108:111], v[240:255]
    s_waitcnt lgkmcnt(9)
    v_mfma_f32_32x32x16_bf16 v[240:255], v[224:227], v[112:115], v[240:255]
    s_waitcnt lgkmcnt(6)
    v_mfma_f32_32x32x16_bf16 v[240:255], v[228:231], v[116:119], v[240:255]
    s_waitcnt lgkmcnt(3)
    v_mfma_f32_32x32x16_bf16 v[240:255], v[232:235], v[120:123], v[240:255]
    s_waitcnt lgkmcnt(0)
    v_mfma_f32_32x32x16_bf16 v[240:255], v[236:239], v[124:127], v[240:255]
    s_nop 7
    s_nop 7
    v_and_b32 v3, 31, v2
    v_cmp_eq_u32 vcc, 28, v3
    v_cmp_lt_u32 s[52:53], 28, v3
    v_mov_b32 v4, 1.0
    v_mov_b32 v5, 0
    v_cndmask_b32 v240, v240, v4, vcc
    v_cndmask_b32 v241, v241, v4, vcc
    v_cndmask_b32 v242, v242, v4, vcc
    v_cndmask_b32 v243, v243, v4, vcc
    v_cndmask_b32 v244, v244, v4, vcc
    v_cndmask_b32 v245, v245, v4, vcc
    v_cndmask_b32 v246, v246, v4, vcc
    v_cndmask_b32 v247, v247, v4, vcc
    v_cndmask_b32 v248, v248, v4, vcc
    v_cndmask_b32 v249, v249, v4, vcc
    v_cndmask_b32 v250, v250, v4, vcc
    v_cndmask_b32 v251, v251, v4, vcc
    v_cndmask_b32 v252, v252, v4, vcc
    v_cndmask_b32 v253, v253, v4, vcc
    v_cndmask_b32 v254, v254, v4, vcc
    v_cndmask_b32 v255, v255, v4, vcc
    v_cndmask_b32 v240, v240, v5, s[52:53]
    v_cndmask_b32 v241, v241, v5, s[52:53]
    v_cndmask_b32 v242, v242, v5, s[52:53]
    v_cndmask_b32 v243, v243, v5, s[52:53]
    v_cndmask_b32 v244, v244, v5, s[52:53]
    v_cndmask_b32 v245, v245, v5, s[52:53]
    v_cndmask_b32 v246, v246, v5, s[52:53]
    v_cndmask_b32 v247, v247, v5, s[52:53]
    v_cndmask_b32 v248, v248, v5, s[52:53]
    v_cndmask_b32 v249, v249, v5, s[52:53]
    v_cndmask_b32 v250, v250, v5, s[52:53]
    v_cndmask_b32 v251, v251, v5, s[52:53]
    v_cndmask_b32 v252, v252, v5, s[52:53]
    v_cndmask_b32 v253, v253, v5, s[52:53]
    v_cndmask_b32 v254, v254, v5, s[52:53]
    v_cndmask_b32 v255, v255, v5, s[52:53]
    v_cvt_pk_bf16_f32 v64, v240, v241
    v_cvt_pk_bf16_f32 v65, v242, v243
    v_cvt_pk_bf16_f32 v66, v244, v245
    v_cvt_pk_bf16_f32 v67, v246, v247
    v_cvt_pk_bf16_f32 v68, v248, v249
    v_cvt_pk_bf16_f32 v69, v250, v251
    v_cvt_pk_bf16_f32 v70, v252, v253
    v_cvt_pk_bf16_f32 v71, v254, v255
    s_lshl_b32 s48, s41, 12
    s_add_u32 s48, s48, 2099200
    buffer_store_dwordx4 v[64:67], v6, s[24:27], s48 offen
    buffer_store_dwordx4 v[68:71], v6, s[24:27], s48 offen offset:1024
K1_END:
    s_endpgm
.section .rodata,"a"
.p2align 6
.amdhsa_kernel k1_kernel
  .amdhsa_next_free_vgpr 256
  .amdhsa_next_free_sgpr 102
  .amdhsa_accum_offset 256
  .amdhsa_group_segment_fixed_size 0
  .amdhsa_kernarg_size 104
  .amdhsa_user_sgpr_count 2
  .amdhsa_user_sgpr_kernarg_segment_ptr 1
  .amdhsa_system_sgpr_workgroup_id_x 1
.end_amdhsa_kernel
.text
.globl k2_kernel
.p2align 8
.type k2_kernel,@function
k2_kernel:
    s_cmp_ge_u32 s2, 256
    s_cbranch_scc1 K2_END
    s_load_dwordx2 s[4:5], s[0:1], 96
    v_lshrrev_b32 v1, 6, v0
    v_and_b32 v2, 63, v0
    v_readfirstlane_b32 s30, v1
    s_lshr_b32 s31, s2, 4
    s_and_b32 s32, s2, 15
    s_lshl_b32 s33, s32, 2
    s_add_u32 s33, s33, s30
    v_lshlrev_b32 v1, 4, v2
    s_waitcnt lgkmcnt(0)
    s_mov_b32 s8, s4
    s_and_b32 s9, s5, 0xffff
    s_mov_b32 s10, 67108864
    s_mov_b32 s11, 0x00020000
    s_cmp_eq_u32 s30, 4
    s_cbranch_scc1 K2_LOADER
    s_lshl_b32 s34, s31, 6
    s_add_u32 s34, s34, s33
    s_lshl_b32 s34, s34, 11
    s_add_u32 s34, s34, 0
    buffer_load_dwordx4 v[16:19], v1, s[8:11], s34 offen
    buffer_load_dwordx4 v[20:23], v1, s[8:11], s34 offen offset:1024
    s_lshl_b32 s35, s30, 13
    s_add_u32 s40, s35, 2097152
    s_mov_b32 s41, s35
    s_mov_b32 m0, s41
    s_add_u32 s41, s41, 4096
    buffer_load_dwordx4 v1, s[8:11], s40 offen offset:0 lds
    buffer_load_dwordx4 v1, s[8:11], s40 offen offset:1024 lds
    buffer_load_dwordx4 v1, s[8:11], s40 offen offset:2048 lds
    buffer_load_dwordx4 v1, s[8:11], s40 offen offset:3072 lds
    s_add_u32 s40, s40, 4096
    s_mov_b32 m0, s41
    s_add_u32 s41, s41, 4096
    buffer_load_dwordx4 v1, s[8:11], s40 offen offset:0 lds
    buffer_load_dwordx4 v1, s[8:11], s40 offen offset:1024 lds
    buffer_load_dwordx4 v1, s[8:11], s40 offen offset:2048 lds
    buffer_load_dwordx4 v1, s[8:11], s40 offen offset:3072 lds
    s_add_u32 s40, s40, 4096
    v_lshrrev_b32 v4, 2, v1
    s_mov_b32 s36, 10420224
    buffer_load_dword v5, v4, s[8:11], s36 offen
    v_mov_b32 v72, 0
    v_mov_b32 v24, 0
    v_mov_b32 v73, 0
    v_mov_b32 v25, 0
    v_mov_b32 v74, 0
    v_mov_b32 v26, 0
    v_mov_b32 v75, 0
    v_mov_b32 v27, 0
    v_mov_b32 v76, 0
    v_mov_b32 v28, 0
    v_mov_b32 v77, 0
    v_mov_b32 v29, 0
    v_mov_b32 v78, 0
    v_mov_b32 v30, 0
    v_mov_b32 v79, 0
    v_mov_b32 v31, 0
    v_mov_b32 v80, 0
    v_mov_b32 v32, 0
    v_mov_b32 v81, 0
    v_mov_b32 v33, 0
    v_mov_b32 v82, 0
    v_mov_b32 v34, 0
    v_mov_b32 v83, 0
    v_mov_b32 v35, 0
    v_mov_b32 v84, 0
    v_mov_b32 v36, 0
    v_mov_b32 v85, 0
    v_mov_b32 v37, 0
    v_mov_b32 v86, 0
    v_mov_b32 v38, 0
    v_mov_b32 v87, 0
    v_mov_b32 v39, 0
    v_mov_b32 v2, v1
    v_add_u32 v3, 32768, v1
    s_waitcnt vmcnt(0)
    s_barrier
    ds_read_b128 v[96:99], v2 offset:0
    ds_read_b128 v[100:103], v2 offset:1024
    ds_read_b128 v[104:107], v2 offset:4096
    ds_read_b128 v[108:111], v2 offset:5120
    ds_read_b128 v[112:115], v2 offset:2048
    ds_read_b128 v[116:119], v2 offset:3072
    s_nop 1
    v_max_f32_dpp v5, v5, v5 row_shr:1 row_mask:0xf bank_mask:0xf
    s_nop 1
    v_max_f32_dpp v5, v5, v5 row_shr:2 row_mask:0xf bank_mask:0xf
    s_nop 1
    v_max_f32_dpp v5, v5, v5 row_shr:4 row_mask:0xf bank_mask:0xf
    s_nop 1
    v_max_f32_dpp v5, v5, v5 row_shr:8 row_mask:0xf bank_mask:0xf
    s_nop 1
    v_max_f32_dpp v5, v5, v5 row_bcast:15 row_mask:0xa bank_mask:0xf
    s_nop 1
    v_max_f32_dpp v5, v5, v5 row_bcast:31 row_mask:0xc bank_mask:0xf
    v_mov_b32 v6, 0
    v_lshlrev_b32 v7, 16, v16
    v_and_b32 v8, 0xffff0000, v16
    v_fmac_f32 v6, v7, v7
    v_fmac_f32 v6, v8, v8
    v_lshlrev_b32 v7, 16, v17
    v_and_b32 v8, 0xffff0000, v17
    v_fmac_f32 v6, v7, v7
    v_fmac_f32 v6, v8, v8
    v_lshlrev_b32 v7, 16, v18
    v_and_b32 v8, 0xffff0000, v18
    v_fmac_f32 v6, v7, v7
    v_fmac_f32 v6, v8, v8
    v_lshlrev_b32 v7, 16, v19
    v_and_b32 v8, 0xffff0000, v19
    v_fmac_f32 v6, v7, v7
    v_fmac_f32 v6, v8, v8
    v_lshlrev_b32 v7, 16, v20
    v_and_b32 v8, 0xffff0000, v20
    v_fmac_f32 v6, v7, v7
    v_fmac_f32 v6, v8, v8
    v_lshlrev_b32 v7, 16, v21
    v_and_b32 v8, 0xffff0000, v21
    v_fmac_f32 v6, v7, v7
    v_fmac_f32 v6, v8, v8
    v_lshlrev_b32 v7, 16, v22
    v_and_b32 v8, 0xffff0000, v22
    v_fmac_f32 v6, v7, v7
    v_fmac_f32 v6, v8, v8
    v_lshlrev_b32 v7, 16, v23
    v_and_b32 v8, 0xffff0000, v23
    v_fmac_f32 v6, v7, v7
    v_fmac_f32 v6, v8, v8
    v_readlane_b32 s37, v5, 63
    v_mov_b32 v7, v6
    s_nop 1
    v_permlane32_swap_b32 v6, v7
    v_add_f32 v6, v6, v7
    v_mul_f32 v6, s37, v6
    v_mul_f32 v6, 0x3f866666, v6
    s_mov_b32 s38, 0x45100000
    v_cmp_ge_f32 vcc, s38, v6
    v_sqrt_f32 v7, v6
    s_waitcnt lgkmcnt(0)
    s_cmp_eq_u64 vcc, exec
    s_cbranch_scc0 K2_SAFE
    v_mul_f32 v7, 0xbf8020c5, v7
    v_mov_b32 v24, v7
    v_mov_b32 v25, v7
    v_mov_b32 v26, v7
    v_mov_b32 v27, v7
    v_mov_b32 v28, v7
    v_mov_b32 v29, v7
    v_mov_b32 v30, v7
    v_mov_b32 v31, v7
    v_mov_b32 v32, v7
    v_mov_b32 v33, v7
    v_mov_b32 v34, v7
    v_mov_b32 v35, v7
    v_mov_b32 v36, v7
    v_mov_b32 v37, v7
    v_mov_b32 v38, v7
    v_mov_b32 v39, v7
    s_nop 1
    v_mfma_f32_32x32x16_bf16 v[40:55], v[96:99], v[16:19], v[24:39]
    v_mfma_f32_32x32x16_bf16 v[40:55], v[100:103], v[20:23], v[40:55]
    s_nop 7
    s_nop 7
    v_exp_f32 v40, v40
    v_exp_f32 v41, v41
    v_exp_f32 v42, v42
    v_exp_f32 v43, v43
    s_mov_b32 s44, 0
    s_branch K2F_LOOP
K2_SAFE:
    v_mfma_f32_32x32x16_bf16 v[40:55], v[96:99], v[16:19], 0
    v_mfma_f32_32x32x16_bf16 v[40:55], v[100:103], v[20:23], v[40:55]
    s_nop 7
    s_nop 7
    v_max3_f32 v4, v40, v41, v42
    v_max3_f32 v5, v43, v44, v45
    v_max3_f32 v6, v46, v47, v48
    v_max3_f32 v7, v49, v50, v51
    v_max3_f32 v4, v4, v52, v53
    v_max3_f32 v5, v5, v54, v55
    v_max3_f32 v4, v4, v6, v7
    v_max_f32 v4, v4, v5
    s_nop 7
    s_nop 7
    v_mov_b32 v5, v4
    s_nop 1
    v_permlane32_swap_b32 v4, v5
    v_max_f32 v4, v4, v5
    v_sub_f32 v40, v40, v4
    v_sub_f32 v41, v41, v4
    v_sub_f32 v42, v42, v4
    v_sub_f32 v43, v43, v4
    v_sub_f32 v44, v44, v4
    v_sub_f32 v45, v45, v4
    v_sub_f32 v46, v46, v4
    v_sub_f32 v47, v47, v4
    v_sub_f32 v48, v48, v4
    v_sub_f32 v49, v49, v4
    v_sub_f32 v50, v50, v4
    v_sub_f32 v51, v51, v4
    v_sub_f32 v52, v52, v4
    v_sub_f32 v53, v53, v4
    v_sub_f32 v54, v54, v4
    v_sub_f32 v55, v55, v4
    v_sub_f32 v24, v24, v4
    v_sub_f32 v25, v25, v4
    v_sub_f32 v26, v26, v4
    v_sub_f32 v27, v27, v4
    v_sub_f32 v28, v28, v4
    v_sub_f32 v29, v29, v4
    v_sub_f32 v30, v30, v4
    v_sub_f32 v31, v31, v4
    v_sub_f32 v32, v32, v4
    v_sub_f32 v33, v33, v4
    v_sub_f32 v34, v34, v4
    v_sub_f32 v35, v35, v4
    v_sub_f32 v36, v36, v4
    v_sub_f32 v37, v37, v4
    v_sub_f32 v38, v38, v4
    v_sub_f32 v39, v39, v4
    v_exp_f32 v40, v40
    v_exp_f32 v41, v41
    v_exp_f32 v42, v42
    v_exp_f32 v43, v43
    s_mov_b32 s44, 0
    s_mov_b32 s45, 0x41000000
K2_LOOP:
    v_mfma_f32_32x32x16_bf16 v[56:71], v[104:107], v[16:19], v[24:39]
    ds_read_b128 v[96:99], v2 offset:8192
    ds_read_b128 v[100:103], v2 offset:9216
    v_exp_f32 v44, v44
    v_exp_f32 v45, v45
    v_exp_f32 v46, v46
    v_exp_f32 v47, v47
    v_mfma_f32_32x32x16_bf16 v[56:71], v[108:111], v[20:23], v[56:71]
    ds_read_b128 v[120:123], v2 offset:6144
    ds_read_b128 v[124:127], v2 offset:7168
    v_exp_f32 v48, v48
    v_cvt_pk_bf16_f32 v88, v40, v41
    v_cvt_pk_bf16_f32 v89, v42, v43
    v_cvt_pk_bf16_f32 v90, v44, v45
    v_cvt_pk_bf16_f32 v91, v46, v47
    v_exp_f32 v49, v49
    v_exp_f32 v50, v50
    v_mfma_f32_32x32x16_bf16 v[72:87], v[112:115], v[88:91], v[72:87]
    v_exp_f32 v51, v51
    v_exp_f32 v52, v52
    v_max3_f32 v4, v56, v57, v58
    v_max3_f32 v5, v59, v60, v61
    v_exp_f32 v53, v53
    v_max3_f32 v6, v62, v63, v64
    v_max3_f32 v7, v65, v66, v67
    v_exp_f32 v54, v54
    v_max3_f32 v4, v4, v68, v69
    v_max3_f32 v5, v5, v70, v71
    v_exp_f32 v55, v55
    v_max3_f32 v6, v6, v7, v4
    v_cvt_pk_bf16_f32 v92, v48, v49
    v_max_f32 v6, v6, v5
    v_cvt_pk_bf16_f32 v93, v50, v51
    v_cmp_lt_f32 vcc, s45, v6
    v_cvt_pk_bf16_f32 v94, v52, v53
    v_cvt_pk_bf16_f32 v95, v54, v55
    s_nop 1
    v_mfma_f32_32x32x16_bf16 v[72:87], v[116:119], v[92:95], v[72:87]
    s_waitcnt lgkmcnt(0)
    s_cbranch_vccnz K2_R_K2a0
K2_B_K2a0:
    v_exp_f32 v56, v56
    v_exp_f32 v57, v57
    v_exp_f32 v58, v58
    v_exp_f32 v59, v59
    v_mfma_f32_32x32x16_bf16 v[40:55], v[96:99], v[16:19], v[24:39]
    ds_read_b128 v[104:107], v2 offset:12288
    ds_read_b128 v[108:111], v2 offset:13312
    v_exp_f32 v60, v60
    v_exp_f32 v61, v61
    v_exp_f32 v62, v62
    v_exp_f32 v63, v63
    v_mfma_f32_32x32x16_bf16 v[40:55], v[100:103], v[20:23], v[40:55]
    ds_read_b128 v[112:115], v2 offset:10240
    ds_read_b128 v[116:119], v2 offset:11264
    v_exp_f32 v64, v64
    v_cvt_pk_bf16_f32 v88, v56, v57
    v_cvt_pk_bf16_f32 v89, v58, v59
    v_cvt_pk_bf16_f32 v90, v60, v61
    v_cvt_pk_bf16_f32 v91, v62, v63
    v_exp_f32 v65, v65
    v_exp_f32 v66, v66
    v_mfma_f32_32x32x16_bf16 v[72:87], v[120:123], v[88:91], v[72:87]
    v_exp_f32 v67, v67
    v_exp_f32 v68, v68
    v_max3_f32 v4, v40, v41, v42
    v_max3_f32 v5, v43, v44, v45
    v_exp_f32 v69, v69
    v_max3_f32 v6, v46, v47, v48
    v_max3_f32 v7, v49, v50, v51
    v_exp_f32 v70, v70
    v_max3_f32 v4, v4, v52, v53
    v_max3_f32 v5, v5, v54, v55
    v_exp_f32 v71, v71
    v_max3_f32 v6, v6, v7, v4
    v_cvt_pk_bf16_f32 v92, v64, v65
    v_max_f32 v6, v6, v5
    v_cvt_pk_bf16_f32 v93, v66, v67
    v_cmp_lt_f32 vcc, s45, v6
    v_cvt_pk_bf16_f32 v94, v68, v69
    v_cvt_pk_bf16_f32 v95, v70, v71
    s_nop 1
    v_mfma_f32_32x32x16_bf16 v[72:87], v[124:127], v[92:95], v[72:87]
    s_waitcnt lgkmcnt(0)
    s_cbranch_vccnz K2_R_K2a1
K2_B_K2a1:
    v_exp_f32 v40, v40
    v_exp_f32 v41, v41
    v_exp_f32 v42, v42
    v_exp_f32 v43, v43
    v_mfma_f32_32x32x16_bf16 v[56:71], v[104:107], v[16:19], v[24:39]
    ds_read_b128 v[96:99], v2 offset:16384
    ds_read_b128 v[100:103], v2 offset:17408
    v_exp_f32 v44, v44
    v_exp_f32 v45, v45
    v_exp_f32 v46, v46
    v_exp_f32 v47, v47
    v_mfma_f32_32x32x16_bf16 v[56:71], v[108:111], v[20:23], v[56:71]
    ds_read_b128 v[120:123], v2 offset:14336
    ds_read_b128 v[124:127], v2 offset:15360
    v_exp_f32 v48, v48
    v_cvt_pk_bf16_f32 v88, v40, v41
    v_cvt_pk_bf16_f32 v89, v42, v43
    v_cvt_pk_bf16_f32 v90, v44, v45
    v_cvt_pk_bf16_f32 v91, v46, v47
    v_exp_f32 v49, v49
    v_exp_f32 v50, v50
    v_mfma_f32_32x32x16_bf16 v[72:87], v[112:115], v[88:91], v[72:87]
    v_exp_f32 v51, v51
    v_exp_f32 v52, v52
    v_max3_f32 v4, v56, v57, v58
    v_max3_f32 v5, v59, v60, v61
    v_exp_f32 v53, v53
    v_max3_f32 v6, v62, v63, v64
    v_max3_f32 v7, v65, v66, v67
    v_exp_f32 v54, v54
    v_max3_f32 v4, v4, v68, v69
    v_max3_f32 v5, v5, v70, v71
    v_exp_f32 v55, v55
    v_max3_f32 v6, v6, v7, v4
    v_cvt_pk_bf16_f32 v92, v48, v49
    v_max_f32 v6, v6, v5
    v_cvt_pk_bf16_f32 v93, v50, v51
    v_cmp_lt_f32 vcc, s45, v6
    v_cvt_pk_bf16_f32 v94, v52, v53
    v_cvt_pk_bf16_f32 v95, v54, v55
    s_nop 1
    v_mfma_f32_32x32x16_bf16 v[72:87], v[116:119], v[92:95], v[72:87]
    s_waitcnt lgkmcnt(0)
    s_cbranch_vccnz K2_R_K2a2
K2_B_K2a2:
    v_exp_f32 v56, v56
    v_exp_f32 v57, v57
    v_exp_f32 v58, v58
    v_exp_f32 v59, v59
    v_mfma_f32_32x32x16_bf16 v[40:55], v[96:99], v[16:19], v[24:39]
    ds_read_b128 v[104:107], v2 offset:20480
    ds_read_b128 v[108:111], v2 offset:21504
    v_exp_f32 v60, v60
    v_exp_f32 v61, v61
    v_exp_f32 v62, v62
    v_exp_f32 v63, v63
    v_mfma_f32_32x32x16_bf16 v[40:55], v[100:103], v[20:23], v[40:55]
    ds_read_b128 v[112:115], v2 offset:18432
    ds_read_b128 v[116:119], v2 offset:19456
    v_exp_f32 v64, v64
    v_cvt_pk_bf16_f32 v88, v56, v57
    v_cvt_pk_bf16_f32 v89, v58, v59
    v_cvt_pk_bf16_f32 v90, v60, v61
    v_cvt_pk_bf16_f32 v91, v62, v63
    v_exp_f32 v65, v65
    v_exp_f32 v66, v66
    v_mfma_f32_32x32x16_bf16 v[72:87], v[120:123], v[88:91], v[72:87]
    v_exp_f32 v67, v67
    v_exp_f32 v68, v68
    v_max3_f32 v4, v40, v41, v42
    v_max3_f32 v5, v43, v44, v45
    v_exp_f32 v69, v69
    v_max3_f32 v6, v46, v47, v48
    v_max3_f32 v7, v49, v50, v51
    v_exp_f32 v70, v70
    v_max3_f32 v4, v4, v52, v53
    v_max3_f32 v5, v5, v54, v55
    v_exp_f32 v71, v71
    v_max3_f32 v6, v6, v7, v4
    v_cvt_pk_bf16_f32 v92, v64, v65
    v_max_f32 v6, v6, v5
    v_cvt_pk_bf16_f32 v93, v66, v67
    v_cmp_lt_f32 vcc, s45, v6
    v_cvt_pk_bf16_f32 v94, v68, v69
    v_cvt_pk_bf16_f32 v95, v70, v71
    s_nop 1
    v_mfma_f32_32x32x16_bf16 v[72:87], v[124:127], v[92:95], v[72:87]
    s_waitcnt lgkmcnt(0)
    s_cbranch_vccnz K2_R_K2a3
K2_B_K2a3:
    v_exp_f32 v40, v40
    v_exp_f32 v41, v41
    v_exp_f32 v42, v42
    v_exp_f32 v43, v43
    v_mfma_f32_32x32x16_bf16 v[56:71], v[104:107], v[16:19], v[24:39]
    ds_read_b128 v[96:99], v2 offset:24576
    ds_read_b128 v[100:103], v2 offset:25600
    v_exp_f32 v44, v44
    v_exp_f32 v45, v45
    v_exp_f32 v46, v46
    v_exp_f32 v47, v47
    v_mfma_f32_32x32x16_bf16 v[56:71], v[108:111], v[20:23], v[56:71]
    ds_read_b128 v[120:123], v2 offset:22528
    ds_read_b128 v[124:127], v2 offset:23552
    v_exp_f32 v48, v48
    v_cvt_pk_bf16_f32 v88, v40, v41
    v_cvt_pk_bf16_f32 v89, v42, v43
    v_cvt_pk_bf16_f32 v90, v44, v45
    v_cvt_pk_bf16_f32 v91, v46, v47
    v_exp_f32 v49, v49
    v_exp_f32 v50, v50
    v_mfma_f32_32x32x16_bf16 v[72:87], v[112:115], v[88:91], v[72:87]
    v_exp_f32 v51, v51
    v_exp_f32 v52, v52
    v_max3_f32 v4, v56, v57, v58
    v_max3_f32 v5, v59, v60, v61
    v_exp_f32 v53, v53
    v_max3_f32 v6, v62, v63, v64
    v_max3_f32 v7, v65, v66, v67
    v_exp_f32 v54, v54
    v_max3_f32 v4, v4, v68, v69
    v_max3_f32 v5, v5, v70, v71
    v_exp_f32 v55, v55
    v_max3_f32 v6, v6, v7, v4
    v_cvt_pk_bf16_f32 v92, v48, v49
    v_max_f32 v6, v6, v5
    v_cvt_pk_bf16_f32 v93, v50, v51
    v_cmp_lt_f32 vcc, s45, v6
    v_cvt_pk_bf16_f32 v94, v52, v53
    v_cvt_pk_bf16_f32 v95, v54, v55
    s_nop 1
    v_mfma_f32_32x32x16_bf16 v[72:87], v[116:119], v[92:95], v[72:87]
    s_waitcnt lgkmcnt(0)
    s_cbranch_vccnz K2_R_K2a4
K2_B_K2a4:
    v_exp_f32 v56, v56
    v_exp_f32 v57, v57
    v_exp_f32 v58, v58
    v_exp_f32 v59, v59
    v_mfma_f32_32x32x16_bf16 v[40:55], v[96:99], v[16:19], v[24:39]
    ds_read_b128 v[104:107], v2 offset:28672
    ds_read_b128 v[108:111], v2 offset:29696
    v_exp_f32 v60, v60
    v_exp_f32 v61, v61
    v_exp_f32 v62, v62
    v_exp_f32 v63, v63
    v_mfma_f32_32x32x16_bf16 v[40:55], v[100:103], v[20:23], v[40:55]
    ds_read_b128 v[112:115], v2 offset:26624
    ds_read_b128 v[116:119], v2 offset:27648
    v_exp_f32 v64, v64
    v_cvt_pk_bf16_f32 v88, v56, v57
    v_cvt_pk_bf16_f32 v89, v58, v59
    v_cvt_pk_bf16_f32 v90, v60, v61
    v_cvt_pk_bf16_f32 v91, v62, v63
    v_exp_f32 v65, v65
    v_exp_f32 v66, v66
    v_mfma_f32_32x32x16_bf16 v[72:87], v[120:123], v[88:91], v[72:87]
    v_exp_f32 v67, v67
    v_exp_f32 v68, v68
    v_max3_f32 v4, v40, v41, v42
    v_max3_f32 v5, v43, v44, v45
    v_exp_f32 v69, v69
    v_max3_f32 v6, v46, v47, v48
    v_max3_f32 v7, v49, v50, v51
    v_exp_f32 v70, v70
    v_max3_f32 v4, v4, v52, v53
    v_max3_f32 v5, v5, v54, v55
    v_exp_f32 v71, v71
    v_max3_f32 v6, v6, v7, v4
    v_cvt_pk_bf16_f32 v92, v64, v65
    v_max_f32 v6, v6, v5
    v_cvt_pk_bf16_f32 v93, v66, v67
    v_cmp_lt_f32 vcc, s45, v6
    v_cvt_pk_bf16_f32 v94, v68, v69
    v_cvt_pk_bf16_f32 v95, v70, v71
    s_nop 1
    v_mfma_f32_32x32x16_bf16 v[72:87], v[124:127], v[92:95], v[72:87]
    s_waitcnt lgkmcnt(0)
    s_cbranch_vccnz K2_R_K2a5
K2_B_K2a5:
    v_exp_f32 v40, v40
    v_exp_f32 v41, v41
    v_exp_f32 v42, v42
    v_exp_f32 v43, v43
    s_barrier
    v_mfma_f32_32x32x16_bf16 v[56:71], v[104:107], v[16:19], v[24:39]
    ds_read_b128 v[96:99], v3 offset:0
    ds_read_b128 v[100:103], v3 offset:1024
    v_exp_f32 v44, v44
    v_exp_f32 v45, v45
    v_exp_f32 v46, v46
    v_exp_f32 v47, v47
    v_mfma_f32_32x32x16_bf16 v[56:71], v[108:111], v[20:23], v[56:71]
    ds_read_b128 v[120:123], v2 offset:30720
    ds_read_b128 v[124:127], v2 offset:31744
    v_exp_f32 v48, v48
    v_cvt_pk_bf16_f32 v88, v40, v41
    v_cvt_pk_bf16_f32 v89, v42, v43
    v_cvt_pk_bf16_f32 v90, v44, v45
    v_cvt_pk_bf16_f32 v91, v46, v47
    v_exp_f32 v49, v49
    v_exp_f32 v50, v50
    v_mfma_f32_32x32x16_bf16 v[72:87], v[112:115], v[88:91], v[72:87]
    v_exp_f32 v51, v51
    v_exp_f32 v52, v52
    v_max3_f32 v4, v56, v57, v58
    v_max3_f32 v5, v59, v60, v61
    v_exp_f32 v53, v53
    v_max3_f32 v6, v62, v63, v64
    v_max3_f32 v7, v65, v66, v67
    v_exp_f32 v54, v54
    v_max3_f32 v4, v4, v68, v69
    v_max3_f32 v5, v5, v70, v71
    v_exp_f32 v55, v55
    v_max3_f32 v6, v6, v7, v4
    v_cvt_pk_bf16_f32 v92, v48, v49
    v_max_f32 v6, v6, v5
    v_cvt_pk_bf16_f32 v93, v50, v51
    v_cmp_lt_f32 vcc, s45, v6
    v_cvt_pk_bf16_f32 v94, v52, v53
    v_cvt_pk_bf16_f32 v95, v54, v55
    s_nop 1
    v_mfma_f32_32x32x16_bf16 v[72:87], v[116:119], v[92:95], v[72:87]
    s_waitcnt lgkmcnt(0)
    s_cbranch_vccnz K2_R_K2a6
K2_B_K2a6:
    v_exp_f32 v56, v56
    v_exp_f32 v57, v57
    v_exp_f32 v58, v58
    v_exp_f32 v59, v59
    v_mfma_f32_32x32x16_bf16 v[40:55], v[96:99], v[16:19], v[24:39]
    ds_read_b128 v[104:107], v3 offset:4096
    ds_read_b128 v[108:111], v3 offset:5120
    v_exp_f32 v60, v60
    v_exp_f32 v61, v61
    v_exp_f32 v62, v62
    v_exp_f32 v63, v63
    v_mfma_f32_32x32x16_bf16 v[40:55], v[100:103], v[20:23], v[40:55]
    ds_read_b128 v[112:115], v3 offset:2048
    ds_read_b128 v[116:119], v3 offset:3072
    v_exp_f32 v64, v64
    v_cvt_pk_bf16_f32 v88, v56, v57
    v_cvt_pk_bf16_f32 v89, v58, v59
    v_cvt_pk_bf16_f32 v90, v60, v61
    v_cvt_pk_bf16_f32 v91, v62, v63
    v_exp_f32 v65, v65
    v_exp_f32 v66, v66
    v_mfma_f32_32x32x16_bf16 v[72:87], v[120:123], v[88:91], v[72:87]
    v_exp_f32 v67, v67
    v_exp_f32 v68, v68
    v_max3_f32 v4, v40, v41, v42
    v_max3_f32 v5, v43, v44, v45
    v_exp_f32 v69, v69
    v_max3_f32 v6, v46, v47, v48
    v_max3_f32 v7, v49, v50, v51
    v_exp_f32 v70, v70
    v_max3_f32 v4, v4, v52, v53
    v_max3_f32 v5, v5, v54, v55
    v_exp_f32 v71, v71
    v_max3_f32 v6, v6, v7, v4
    v_cvt_pk_bf16_f32 v92, v64, v65
    v_max_f32 v6, v6, v5
    v_cvt_pk_bf16_f32 v93, v66, v67
    v_cmp_lt_f32 vcc, s45, v6
    v_cvt_pk_bf16_f32 v94, v68, v69
    v_cvt_pk_bf16_f32 v95, v70, v71
    s_nop 1
    v_mfma_f32_32x32x16_bf16 v[72:87], v[124:127], v[92:95], v[72:87]
    s_waitcnt lgkmcnt(0)
    s_cbranch_vccnz K2_R_K2a7
K2_B_K2a7:
    v_exp_f32 v40, v40
    v_exp_f32 v41, v41
    v_exp_f32 v42, v42
    v_exp_f32 v43, v43
    v_mov_b32 v2, v3
    v_add_u32 v3, 32768, v3
    v_and_b32 v3, 0x1ffff, v3
    s_add_u32 s44, s44, 1
    s_cmp_lt_u32 s44, 7
    s_cbranch_scc1 K2_LOOP
    v_mfma_f32_32x32x16_bf16 v[56:71], v[104:107], v[16:19], v[24:39]
    ds_read_b128 v[96:99], v2 offset:8192
    ds_read_b128 v[100:103], v2 offset:9216
    v_exp_f32 v44, v44
    v_exp_f32 v45, v45
    v_exp_f32 v46, v46
    v_exp_f32 v47, v47
    v_mfma_f32_32x32x16_bf16 v[56:71], v[108:111], v[20:23], v[56:71]
    ds_read_b128 v[120:123], v2 offset:6144
    ds_read_b128 v[124:127], v2 offset:7168
    v_exp_f32 v48, v48
    v_cvt_pk_bf16_f32 v88, v40, v41
    v_cvt_pk_bf16_f32 v89, v42, v43
    v_cvt_pk_bf16_f32 v90, v44, v45
    v_cvt_pk_bf16_f32 v91, v46, v47
    v_exp_f32 v49, v49
    v_exp_f32 v50, v50
    v_mfma_f32_32x32x16_bf16 v[72:87], v[112:115], v[88:91], v[72:87]
    v_exp_f32 v51, v51
    v_exp_f32 v52, v52
    v_max3_f32 v4, v56, v57, v58
    v_max3_f32 v5, v59, v60, v61
    v_exp_f32 v53, v53
    v_max3_f32 v6, v62, v63, v64
    v_max3_f32 v7, v65, v66, v67
    v_exp_f32 v54, v54
    v_max3_f32 v4, v4, v68, v69
    v_max3_f32 v5, v5, v70, v71
    v_exp_f32 v55, v55
    v_max3_f32 v6, v6, v7, v4
    v_cvt_pk_bf16_f32 v92, v48, v49
    v_max_f32 v6, v6, v5
    v_cvt_pk_bf16_f32 v93, v50, v51
    v_cmp_lt_f32 vcc, s45, v6
    v_cvt_pk_bf16_f32 v94, v52, v53
    v_cvt_pk_bf16_f32 v95, v54, v55
    s_nop 1
    v_mfma_f32_32x32x16_bf16 v[72:87], v[116:119], v[92:95], v[72:87]
    s_waitcnt lgkmcnt(0)
    s_cbranch_vccnz K2_R_K2b0
K2_B_K2b0:
    v_exp_f32 v56, v56
    v_exp_f32 v57, v57
    v_exp_f32 v58, v58
    v_exp_f32 v59, v59
    v_mfma_f32_32x32x16_bf16 v[40:55], v[96:99], v[16:19], v[24:39]
    ds_read_b128 v[104:107], v2 offset:12288
    ds_read_b128 v[108:111], v2 offset:13312
    v_exp_f32 v60, v60
    v_exp_f32 v61, v61
    v_exp_f32 v62, v62
    v_exp_f32 v63, v63
    v_mfma_f32_32x32x16_bf16 v[40:55], v[100:103], v[20:23], v[40:55]
    ds_read_b128 v[112:115], v2 offset:10240
    ds_read_b128 v[116:119], v2 offset:11264
    v_exp_f32 v64, v64
    v_cvt_pk_bf16_f32 v88, v56, v57
    v_cvt_pk_bf16_f32 v89, v58, v59
    v_cvt_pk_bf16_f32 v90, v60, v61
    v_cvt_pk_bf16_f32 v91, v62, v63
    v_exp_f32 v65, v65
    v_exp_f32 v66, v66
    v_mfma_f32_32x32x16_bf16 v[72:87], v[120:123], v[88:91], v[72:87]
    v_exp_f32 v67, v67
    v_exp_f32 v68, v68
    v_max3_f32 v4, v40, v41, v42
    v_max3_f32 v5, v43, v44, v45
    v_exp_f32 v69, v69
    v_max3_f32 v6, v46, v47, v48
    v_max3_f32 v7, v49, v50, v51
    v_exp_f32 v70, v70
    v_max3_f32 v4, v4, v52, v53
    v_max3_f32 v5, v5, v54, v55
    v_exp_f32 v71, v71
    v_max3_f32 v6, v6, v7, v4
    v_cvt_pk_bf16_f32 v92, v64, v65
    v_max_f32 v6, v6, v5
    v_cvt_pk_bf16_f32 v93, v66, v67
    v_cmp_lt_f32 vcc, s45, v6
    v_cvt_pk_bf16_f32 v94, v68, v69
    v_cvt_pk_bf16_f32 v95, v70, v71
    s_nop 1
    v_mfma_f32_32x32x16_bf16 v[72:87], v[124:127], v[92:95], v[72:87]
    s_waitcnt lgkmcnt(0)
    s_cbranch_vccnz K2_R_K2b1
K2_B_K2b1:
    v_exp_f32 v40, v40
    v_exp_f32 v41, v41
    v_exp_f32 v42, v42
    v_exp_f32 v43, v43
    v_mfma_f32_32x32x16_bf16 v[56:71], v[104:107], v[16:19], v[24:39]
    ds_read_b128 v[96:99], v2 offset:16384
    ds_read_b128 v[100:103], v2 offset:17408
    v_exp_f32 v44, v44
    v_exp_f32 v45, v45
    v_exp_f32 v46, v46
    v_exp_f32 v47, v47
    v_mfma_f32_32x32x16_bf16 v[56:71], v[108:111], v[20:23], v[56:71]
    ds_read_b128 v[120:123], v2 offset:14336
    ds_read_b128 v[124:127], v2 offset:15360
    v_exp_f32 v48, v48
    v_cvt_pk_bf16_f32 v88, v40, v41
    v_cvt_pk_bf16_f32 v89, v42, v43
    v_cvt_pk_bf16_f32 v90, v44, v45
    v_cvt_pk_bf16_f32 v91, v46, v47
    v_exp_f32 v49, v49
    v_exp_f32 v50, v50
    v_mfma_f32_32x32x16_bf16 v[72:87], v[112:115], v[88:91], v[72:87]
    v_exp_f32 v51, v51
    v_exp_f32 v52, v52
    v_max3_f32 v4, v56, v57, v58
    v_max3_f32 v5, v59, v60, v61
    v_exp_f32 v53, v53
    v_max3_f32 v6, v62, v63, v64
    v_max3_f32 v7, v65, v66, v67
    v_exp_f32 v54, v54
    v_max3_f32 v4, v4, v68, v69
    v_max3_f32 v5, v5, v70, v71
    v_exp_f32 v55, v55
    v_max3_f32 v6, v6, v7, v4
    v_cvt_pk_bf16_f32 v92, v48, v49
    v_max_f32 v6, v6, v5
    v_cvt_pk_bf16_f32 v93, v50, v51
    v_cmp_lt_f32 vcc, s45, v6
    v_cvt_pk_bf16_f32 v94, v52, v53
    v_cvt_pk_bf16_f32 v95, v54, v55
    s_nop 1
    v_mfma_f32_32x32x16_bf16 v[72:87], v[116:119], v[92:95], v[72:87]
    s_waitcnt lgkmcnt(0)
    s_cbranch_vccnz K2_R_K2b2
K2_B_K2b2:
    v_exp_f32 v56, v56
    v_exp_f32 v57, v57
    v_exp_f32 v58, v58
    v_exp_f32 v59, v59
    v_mfma_f32_32x32x16_bf16 v[40:55], v[96:99], v[16:19], v[24:39]
    ds_read_b128 v[104:107], v2 offset:20480
    ds_read_b128 v[108:111], v2 offset:21504
    v_exp_f32 v60, v60
    v_exp_f32 v61, v61
    v_exp_f32 v62, v62
    v_exp_f32 v63, v63
    v_mfma_f32_32x32x16_bf16 v[40:55], v[100:103], v[20:23], v[40:55]
    ds_read_b128 v[112:115], v2 offset:18432
    ds_read_b128 v[116:119], v2 offset:19456
    v_exp_f32 v64, v64
    v_cvt_pk_bf16_f32 v88, v56, v57
    v_cvt_pk_bf16_f32 v89, v58, v59
    v_cvt_pk_bf16_f32 v90, v60, v61
    v_cvt_pk_bf16_f32 v91, v62, v63
    v_exp_f32 v65, v65
    v_exp_f32 v66, v66
    v_mfma_f32_32x32x16_bf16 v[72:87], v[120:123], v[88:91], v[72:87]
    v_exp_f32 v67, v67
    v_exp_f32 v68, v68
    v_max3_f32 v4, v40, v41, v42
    v_max3_f32 v5, v43, v44, v45
    v_exp_f32 v69, v69
    v_max3_f32 v6, v46, v47, v48
    v_max3_f32 v7, v49, v50, v51
    v_exp_f32 v70, v70
    v_max3_f32 v4, v4, v52, v53
    v_max3_f32 v5, v5, v54, v55
    v_exp_f32 v71, v71
    v_max3_f32 v6, v6, v7, v4
    v_cvt_pk_bf16_f32 v92, v64, v65
    v_max_f32 v6, v6, v5
    v_cvt_pk_bf16_f32 v93, v66, v67
    v_cmp_lt_f32 vcc, s45, v6
    v_cvt_pk_bf16_f32 v94, v68, v69
    v_cvt_pk_bf16_f32 v95, v70, v71
    s_nop 1
    v_mfma_f32_32x32x16_bf16 v[72:87], v[124:127], v[92:95], v[72:87]
    s_waitcnt lgkmcnt(0)
    s_cbranch_vccnz K2_R_K2b3
K2_B_K2b3:
    v_exp_f32 v40, v40
    v_exp_f32 v41, v41
    v_exp_f32 v42, v42
    v_exp_f32 v43, v43
    v_mfma_f32_32x32x16_bf16 v[56:71], v[104:107], v[16:19], v[24:39]
    ds_read_b128 v[96:99], v2 offset:24576
    ds_read_b128 v[100:103], v2 offset:25600
    v_exp_f32 v44, v44
    v_exp_f32 v45, v45
    v_exp_f32 v46, v46
    v_exp_f32 v47, v47
    v_mfma_f32_32x32x16_bf16 v[56:71], v[108:111], v[20:23], v[56:71]
    ds_read_b128 v[120:123], v2 offset:22528
    ds_read_b128 v[124:127], v2 offset:23552
    v_exp_f32 v48, v48
    v_cvt_pk_bf16_f32 v88, v40, v41
    v_cvt_pk_bf16_f32 v89, v42, v43
    v_cvt_pk_bf16_f32 v90, v44, v45
    v_cvt_pk_bf16_f32 v91, v46, v47
    v_exp_f32 v49, v49
    v_exp_f32 v50, v50
    v_mfma_f32_32x32x16_bf16 v[72:87], v[112:115], v[88:91], v[72:87]
    v_exp_f32 v51, v51
    v_exp_f32 v52, v52
    v_max3_f32 v4, v56, v57, v58
    v_max3_f32 v5, v59, v60, v61
    v_exp_f32 v53, v53
    v_max3_f32 v6, v62, v63, v64
    v_max3_f32 v7, v65, v66, v67
    v_exp_f32 v54, v54
    v_max3_f32 v4, v4, v68, v69
    v_max3_f32 v5, v5, v70, v71
    v_exp_f32 v55, v55
    v_max3_f32 v6, v6, v7, v4
    v_cvt_pk_bf16_f32 v92, v48, v49
    v_max_f32 v6, v6, v5
    v_cvt_pk_bf16_f32 v93, v50, v51
    v_cmp_lt_f32 vcc, s45, v6
    v_cvt_pk_bf16_f32 v94, v52, v53
    v_cvt_pk_bf16_f32 v95, v54, v55
    s_nop 1
    v_mfma_f32_32x32x16_bf16 v[72:87], v[116:119], v[92:95], v[72:87]
    s_waitcnt lgkmcnt(0)
    s_cbranch_vccnz K2_R_K2b4
K2_B_K2b4:
    v_exp_f32 v56, v56
    v_exp_f32 v57, v57
    v_exp_f32 v58, v58
    v_exp_f32 v59, v59
    v_mfma_f32_32x32x16_bf16 v[40:55], v[96:99], v[16:19], v[24:39]
    ds_read_b128 v[104:107], v2 offset:28672
    ds_read_b128 v[108:111], v2 offset:29696
    v_exp_f32 v60, v60
    v_exp_f32 v61, v61
    v_exp_f32 v62, v62
    v_exp_f32 v63, v63
    v_mfma_f32_32x32x16_bf16 v[40:55], v[100:103], v[20:23], v[40:55]
    ds_read_b128 v[112:115], v2 offset:26624
    ds_read_b128 v[116:119], v2 offset:27648
    v_exp_f32 v64, v64
    v_cvt_pk_bf16_f32 v88, v56, v57
    v_cvt_pk_bf16_f32 v89, v58, v59
    v_cvt_pk_bf16_f32 v90, v60, v61
    v_cvt_pk_bf16_f32 v91, v62, v63
    v_exp_f32 v65, v65
    v_exp_f32 v66, v66
    v_mfma_f32_32x32x16_bf16 v[72:87], v[120:123], v[88:91], v[72:87]
    v_exp_f32 v67, v67
    v_exp_f32 v68, v68
    v_max3_f32 v4, v40, v41, v42
    v_max3_f32 v5, v43, v44, v45
    v_exp_f32 v69, v69
    v_max3_f32 v6, v46, v47, v48
    v_max3_f32 v7, v49, v50, v51
    v_exp_f32 v70, v70
    v_max3_f32 v4, v4, v52, v53
    v_max3_f32 v5, v5, v54, v55
    v_exp_f32 v71, v71
    v_max3_f32 v6, v6, v7, v4
    v_cvt_pk_bf16_f32 v92, v64, v65
    v_max_f32 v6, v6, v5
    v_cvt_pk_bf16_f32 v93, v66, v67
    v_cmp_lt_f32 vcc, s45, v6
    v_cvt_pk_bf16_f32 v94, v68, v69
    v_cvt_pk_bf16_f32 v95, v70, v71
    s_nop 1
    v_mfma_f32_32x32x16_bf16 v[72:87], v[124:127], v[92:95], v[72:87]
    s_waitcnt lgkmcnt(0)
    s_cbranch_vccnz K2_R_K2b5
K2_B_K2b5:
    v_exp_f32 v40, v40
    v_exp_f32 v41, v41
    v_exp_f32 v42, v42
    v_exp_f32 v43, v43
    v_mfma_f32_32x32x16_bf16 v[56:71], v[104:107], v[16:19], v[24:39]
    v_exp_f32 v44, v44
    v_exp_f32 v45, v45
    v_exp_f32 v46, v46
    v_exp_f32 v47, v47
    v_mfma_f32_32x32x16_bf16 v[56:71], v[108:111], v[20:23], v[56:71]
    ds_read_b128 v[120:123], v2 offset:30720
    ds_read_b128 v[124:127], v2 offset:31744
    v_exp_f32 v48, v48
    v_cvt_pk_bf16_f32 v88, v40, v41
    v_cvt_pk_bf16_f32 v89, v42, v43
    v_cvt_pk_bf16_f32 v90, v44, v45
    v_cvt_pk_bf16_f32 v91, v46, v47
    v_exp_f32 v49, v49
    v_exp_f32 v50, v50
    v_mfma_f32_32x32x16_bf16 v[72:87], v[112:115], v[88:91], v[72:87]
    v_exp_f32 v51, v51
    v_exp_f32 v52, v52
    v_max3_f32 v4, v56, v57, v58
    v_max3_f32 v5, v59, v60, v61
    v_exp_f32 v53, v53
    v_max3_f32 v6, v62, v63, v64
    v_max3_f32 v7, v65, v66, v67
    v_exp_f32 v54, v54
    v_max3_f32 v4, v4, v68, v69
    v_max3_f32 v5, v5, v70, v71
    v_exp_f32 v55, v55
    v_max3_f32 v6, v6, v7, v4
    v_cvt_pk_bf16_f32 v92, v48, v49
    v_max_f32 v6, v6, v5
    v_cvt_pk_bf16_f32 v93, v50, v51
    v_cmp_lt_f32 vcc, s45, v6
    v_cvt_pk_bf16_f32 v94, v52, v53
    v_cvt_pk_bf16_f32 v95, v54, v55
    s_nop 1
    v_mfma_f32_32x32x16_bf16 v[72:87], v[116:119], v[92:95], v[72:87]
    s_waitcnt lgkmcnt(0)
    s_cbranch_vccnz K2_R_K2b6
K2_B_K2b6:
    v_exp_f32 v56, v56
    v_exp_f32 v57, v57
    v_exp_f32 v58, v58
    v_exp_f32 v59, v59
    v_exp_f32 v60, v60
    v_exp_f32 v61, v61
    v_exp_f32 v62, v62
    v_exp_f32 v63, v63
    v_exp_f32 v64, v64
    v_cvt_pk_bf16_f32 v88, v56, v57
    v_cvt_pk_bf16_f32 v89, v58, v59
    v_cvt_pk_bf16_f32 v90, v60, v61
    v_cvt_pk_bf16_f32 v91, v62, v63
    v_exp_f32 v65, v65
    v_exp_f32 v66, v66
    v_mfma_f32_32x32x16_bf16 v[72:87], v[120:123], v[88:91], v[72:87]
    v_exp_f32 v67, v67
    v_exp_f32 v68, v68
    v_exp_f32 v69, v69
    v_exp_f32 v70, v70
    v_exp_f32 v71, v71
    s_nop 0
    v_cvt_pk_bf16_f32 v92, v64, v65
    v_cvt_pk_bf16_f32 v93, v66, v67
    v_cvt_pk_bf16_f32 v94, v68, v69
    v_cvt_pk_bf16_f32 v95, v70, v71
    s_nop 1
    v_mfma_f32_32x32x16_bf16 v[72:87], v[124:127], v[92:95], v[72:87]
    s_branch K2_EPI
K2F_LOOP:
    v_mfma_f32_32x32x16_bf16 v[56:71], v[104:107], v[16:19], v[24:39]
    ds_read_b128 v[96:99], v2 offset:8192
    ds_read_b128 v[100:103], v2 offset:9216
    v_exp_f32 v44, v44
    v_exp_f32 v45, v45
    v_exp_f32 v46, v46
    v_exp_f32 v47, v47
    v_mfma_f32_32x32x16_bf16 v[56:71], v[108:111], v[20:23], v[56:71]
    ds_read_b128 v[120:123], v2 offset:6144
    ds_read_b128 v[124:127], v2 offset:7168
    v_exp_f32 v48, v48
    v_cvt_pk_bf16_f32 v88, v40, v41
    v_cvt_pk_bf16_f32 v89, v42, v43
    v_cvt_pk_bf16_f32 v90, v44, v45
    v_cvt_pk_bf16_f32 v91, v46, v47
    v_exp_f32 v49, v49
    v_exp_f32 v50, v50
    v_mfma_f32_32x32x16_bf16 v[72:87], v[112:115], v[88:91], v[72:87]
    v_exp_f32 v51, v51
    v_exp_f32 v52, v52
    v_exp_f32 v53, v53
    v_exp_f32 v54, v54
    v_exp_f32 v55, v55
    s_nop 0
    v_cvt_pk_bf16_f32 v92, v48, v49
    v_cvt_pk_bf16_f32 v93, v50, v51
    v_cvt_pk_bf16_f32 v94, v52, v53
    v_cvt_pk_bf16_f32 v95, v54, v55
    s_nop 1
    v_mfma_f32_32x32x16_bf16 v[72:87], v[116:119], v[92:95], v[72:87]
    s_waitcnt lgkmcnt(0)
    v_exp_f32 v56, v56
    v_exp_f32 v57, v57
    v_exp_f32 v58, v58
    v_exp_f32 v59, v59
    v_mfma_f32_32x32x16_bf16 v[40:55], v[96:99], v[16:19], v[24:39]
    ds_read_b128 v[104:107], v2 offset:12288
    ds_read_b128 v[108:111], v2 offset:13312
    v_exp_f32 v60, v60
    v_exp_f32 v61, v61
    v_exp_f32 v62, v62
    v_exp_f32 v63, v63
    v_mfma_f32_32x32x16_bf16 v[40:55], v[100:103], v[20:23], v[40:55]
    ds_read_b128 v[112:115], v2 offset:10240
    ds_read_b128 v[116:119], v2 offset:11264
    v_exp_f32 v64, v64
    v_cvt_pk_bf16_f32 v88, v56, v57
    v_cvt_pk_bf16_f32 v89, v58, v59
    v_cvt_pk_bf16_f32 v90, v60, v61
    v_cvt_pk_bf16_f32 v91, v62, v63
    v_exp_f32 v65, v65
    v_exp_f32 v66, v66
    v_mfma_f32_32x32x16_bf16 v[72:87], v[120:123], v[88:91], v[72:87]
    v_exp_f32 v67, v67
    v_exp_f32 v68, v68
    v_exp_f32 v69, v69
    v_exp_f32 v70, v70
    v_exp_f32 v71, v71
    s_nop 0
    v_cvt_pk_bf16_f32 v92, v64, v65
    v_cvt_pk_bf16_f32 v93, v66, v67
    v_cvt_pk_bf16_f32 v94, v68, v69
    v_cvt_pk_bf16_f32 v95, v70, v71
    s_nop 1
    v_mfma_f32_32x32x16_bf16 v[72:87], v[124:127], v[92:95], v[72:87]
    s_waitcnt lgkmcnt(0)
    v_exp_f32 v40, v40
    v_exp_f32 v41, v41
    v_exp_f32 v42, v42
    v_exp_f32 v43, v43
    v_mfma_f32_32x32x16_bf16 v[56:71], v[104:107], v[16:19], v[24:39]
    ds_read_b128 v[96:99], v2 offset:16384
    ds_read_b128 v[100:103], v2 offset:17408
    v_exp_f32 v44, v44
    v_exp_f32 v45, v45
    v_exp_f32 v46, v46
    v_exp_f32 v47, v47
    v_mfma_f32_32x32x16_bf16 v[56:71], v[108:111], v[20:23], v[56:71]
    ds_read_b128 v[120:123], v2 offset:14336
    ds_read_b128 v[124:127], v2 offset:15360
    v_exp_f32 v48, v48
    v_cvt_pk_bf16_f32 v88, v40, v41
    v_cvt_pk_bf16_f32 v89, v42, v43
    v_cvt_pk_bf16_f32 v90, v44, v45
    v_cvt_pk_bf16_f32 v91, v46, v47
    v_exp_f32 v49, v49
    v_exp_f32 v50, v50
    v_mfma_f32_32x32x16_bf16 v[72:87], v[112:115], v[88:91], v[72:87]
    v_exp_f32 v51, v51
    v_exp_f32 v52, v52
    v_exp_f32 v53, v53
    v_exp_f32 v54, v54
    v_exp_f32 v55, v55
    s_nop 0
    v_cvt_pk_bf16_f32 v92, v48, v49
    v_cvt_pk_bf16_f32 v93, v50, v51
    v_cvt_pk_bf16_f32 v94, v52, v53
    v_cvt_pk_bf16_f32 v95, v54, v55
    s_nop 1
    v_mfma_f32_32x32x16_bf16 v[72:87], v[116:119], v[92:95], v[72:87]
    s_waitcnt lgkmcnt(0)
    v_exp_f32 v56, v56
    v_exp_f32 v57, v57
    v_exp_f32 v58, v58
    v_exp_f32 v59, v59
    v_mfma_f32_32x32x16_bf16 v[40:55], v[96:99], v[16:19], v[24:39]
    ds_read_b128 v[104:107], v2 offset:20480
    ds_read_b128 v[108:111], v2 offset:21504
    v_exp_f32 v60, v60
    v_exp_f32 v61, v61
    v_exp_f32 v62, v62
    v_exp_f32 v63, v63
    v_mfma_f32_32x32x16_bf16 v[40:55], v[100:103], v[20:23], v[40:55]
    ds_read_b128 v[112:115], v2 offset:18432
    ds_read_b128 v[116:119], v2 offset:19456
    v_exp_f32 v64, v64
    v_cvt_pk_bf16_f32 v88, v56, v57
    v_cvt_pk_bf16_f32 v89, v58, v59
    v_cvt_pk_bf16_f32 v90, v60, v61
    v_cvt_pk_bf16_f32 v91, v62, v63
    v_exp_f32 v65, v65
    v_exp_f32 v66, v66
    v_mfma_f32_32x32x16_bf16 v[72:87], v[120:123], v[88:91], v[72:87]
    v_exp_f32 v67, v67
    v_exp_f32 v68, v68
    v_exp_f32 v69, v69
    v_exp_f32 v70, v70
    v_exp_f32 v71, v71
    s_nop 0
    v_cvt_pk_bf16_f32 v92, v64, v65
    v_cvt_pk_bf16_f32 v93, v66, v67
    v_cvt_pk_bf16_f32 v94, v68, v69
    v_cvt_pk_bf16_f32 v95, v70, v71
    s_nop 1
    v_mfma_f32_32x32x16_bf16 v[72:87], v[124:127], v[92:95], v[72:87]
    s_waitcnt lgkmcnt(0)
    v_exp_f32 v40, v40
    v_exp_f32 v41, v41
    v_exp_f32 v42, v42
    v_exp_f32 v43, v43
    v_mfma_f32_32x32x16_bf16 v[56:71], v[104:107], v[16:19], v[24:39]
    ds_read_b128 v[96:99], v2 offset:24576
    ds_read_b128 v[100:103], v2 offset:25600
    v_exp_f32 v44, v44
    v_exp_f32 v45, v45
    v_exp_f32 v46, v46
    v_exp_f32 v47, v47
    v_mfma_f32_32x32x16_bf16 v[56:71], v[108:111], v[20:23], v[56:71]
    ds_read_b128 v[120:123], v2 offset:22528
    ds_read_b128 v[124:127], v2 offset:23552
    v_exp_f32 v48, v48
    v_cvt_pk_bf16_f32 v88, v40, v41
    v_cvt_pk_bf16_f32 v89, v42, v43
    v_cvt_pk_bf16_f32 v90, v44, v45
    v_cvt_pk_bf16_f32 v91, v46, v47
    v_exp_f32 v49, v49
    v_exp_f32 v50, v50
    v_mfma_f32_32x32x16_bf16 v[72:87], v[112:115], v[88:91], v[72:87]
    v_exp_f32 v51, v51
    v_exp_f32 v52, v52
    v_exp_f32 v53, v53
    v_exp_f32 v54, v54
    v_exp_f32 v55, v55
    s_nop 0
    v_cvt_pk_bf16_f32 v92, v48, v49
    v_cvt_pk_bf16_f32 v93, v50, v51
    v_cvt_pk_bf16_f32 v94, v52, v53
    v_cvt_pk_bf16_f32 v95, v54, v55
    s_nop 1
    v_mfma_f32_32x32x16_bf16 v[72:87], v[116:119], v[92:95], v[72:87]
    s_waitcnt lgkmcnt(0)
    v_exp_f32 v56, v56
    v_exp_f32 v57, v57
    v_exp_f32 v58, v58
    v_exp_f32 v59, v59
    v_mfma_f32_32x32x16_bf16 v[40:55], v[96:99], v[16:19], v[24:39]
    ds_read_b128 v[104:107], v2 offset:28672
    ds_read_b128 v[108:111], v2 offset:29696
    v_exp_f32 v60, v60
    v_exp_f32 v61, v61
    v_exp_f32 v62, v62
    v_exp_f32 v63, v63
    v_mfma_f32_32x32x16_bf16 v[40:55], v[100:103], v[20:23], v[40:55]
    ds_read_b128 v[112:115], v2 offset:26624
    ds_read_b128 v[116:119], v2 offset:27648
    v_exp_f32 v64, v64
    v_cvt_pk_bf16_f32 v88, v56, v57
    v_cvt_pk_bf16_f32 v89, v58, v59
    v_cvt_pk_bf16_f32 v90, v60, v61
    v_cvt_pk_bf16_f32 v91, v62, v63
    v_exp_f32 v65, v65
    v_exp_f32 v66, v66
    v_mfma_f32_32x32x16_bf16 v[72:87], v[120:123], v[88:91], v[72:87]
    v_exp_f32 v67, v67
    v_exp_f32 v68, v68
    v_exp_f32 v69, v69
    v_exp_f32 v70, v70
    v_exp_f32 v71, v71
    s_nop 0
    v_cvt_pk_bf16_f32 v92, v64, v65
    v_cvt_pk_bf16_f32 v93, v66, v67
    v_cvt_pk_bf16_f32 v94, v68, v69
    v_cvt_pk_bf16_f32 v95, v70, v71
    s_nop 1
    v_mfma_f32_32x32x16_bf16 v[72:87], v[124:127], v[92:95], v[72:87]
    s_waitcnt lgkmcnt(0)
    v_exp_f32 v40, v40
    v_exp_f32 v41, v41
    v_exp_f32 v42, v42
    v_exp_f32 v43, v43
    s_barrier
    v_mfma_f32_32x32x16_bf16 v[56:71], v[104:107], v[16:19], v[24:39]
    ds_read_b128 v[96:99], v3 offset:0
    ds_read_b128 v[100:103], v3 offset:1024
    v_exp_f32 v44, v44
    v_exp_f32 v45, v45
    v_exp_f32 v46, v46
    v_exp_f32 v47, v47
    v_mfma_f32_32x32x16_bf16 v[56:71], v[108:111], v[20:23], v[56:71]
    ds_read_b128 v[120:123], v2 offset:30720
    ds_read_b128 v[124:127], v2 offset:31744
    v_exp_f32 v48, v48
    v_cvt_pk_bf16_f32 v88, v40, v41
    v_cvt_pk_bf16_f32 v89, v42, v43
    v_cvt_pk_bf16_f32 v90, v44, v45
    v_cvt_pk_bf16_f32 v91, v46, v47
    v_exp_f32 v49, v49
    v_exp_f32 v50, v50
    v_mfma_f32_32x32x16_bf16 v[72:87], v[112:115], v[88:91], v[72:87]
    v_exp_f32 v51, v51
    v_exp_f32 v52, v52
    v_exp_f32 v53, v53
    v_exp_f32 v54, v54
    v_exp_f32 v55, v55
    s_nop 0
    v_cvt_pk_bf16_f32 v92, v48, v49
    v_cvt_pk_bf16_f32 v93, v50, v51
    v_cvt_pk_bf16_f32 v94, v52, v53
    v_cvt_pk_bf16_f32 v95, v54, v55
    s_nop 1
    v_mfma_f32_32x32x16_bf16 v[72:87], v[116:119], v[92:95], v[72:87]
    s_waitcnt lgkmcnt(0)
    v_exp_f32 v56, v56
    v_exp_f32 v57, v57
    v_exp_f32 v58, v58
    v_exp_f32 v59, v59
    v_mfma_f32_32x32x16_bf16 v[40:55], v[96:99], v[16:19], v[24:39]
    ds_read_b128 v[104:107], v3 offset:4096
    ds_read_b128 v[108:111], v3 offset:5120
    v_exp_f32 v60, v60
    v_exp_f32 v61, v61
    v_exp_f32 v62, v62
    v_exp_f32 v63, v63
    v_mfma_f32_32x32x16_bf16 v[40:55], v[100:103], v[20:23], v[40:55]
    ds_read_b128 v[112:115], v3 offset:2048
    ds_read_b128 v[116:119], v3 offset:3072
    v_exp_f32 v64, v64
    v_cvt_pk_bf16_f32 v88, v56, v57
    v_cvt_pk_bf16_f32 v89, v58, v59
    v_cvt_pk_bf16_f32 v90, v60, v61
    v_cvt_pk_bf16_f32 v91, v62, v63
    v_exp_f32 v65, v65
    v_exp_f32 v66, v66
    v_mfma_f32_32x32x16_bf16 v[72:87], v[120:123], v[88:91], v[72:87]
    v_exp_f32 v67, v67
    v_exp_f32 v68, v68
    v_exp_f32 v69, v69
    v_exp_f32 v70, v70
    v_exp_f32 v71, v71
    s_nop 0
    v_cvt_pk_bf16_f32 v92, v64, v65
    v_cvt_pk_bf16_f32 v93, v66, v67
    v_cvt_pk_bf16_f32 v94, v68, v69
    v_cvt_pk_bf16_f32 v95, v70, v71
    s_nop 1
    v_mfma_f32_32x32x16_bf16 v[72:87], v[124:127], v[92:95], v[72:87]
    s_waitcnt lgkmcnt(0)
    v_exp_f32 v40, v40
    v_exp_f32 v41, v41
    v_exp_f32 v42, v42
    v_exp_f32 v43, v43
    v_mov_b32 v2, v3
    v_add_u32 v3, 32768, v3
    v_and_b32 v3, 0x1ffff, v3
    s_add_u32 s44, s44, 1
    s_cmp_lt_u32 s44, 7
    s_cbranch_scc1 K2F_LOOP
    v_mfma_f32_32x32x16_bf16 v[56:71], v[104:107], v[16:19], v[24:39]
    ds_read_b128 v[96:99], v2 offset:8192
    ds_read_b128 v[100:103], v2 offset:9216
    v_exp_f32 v44, v44
    v_exp_f32 v45, v45
    v_exp_f32 v46, v46
    v_exp_f32 v47, v47
    v_mfma_f32_32x32x16_bf16 v[56:71], v[108:111], v[20:23], v[56:71]
    ds_read_b128 v[120:123], v2 offset:6144
    ds_read_b128 v[124:127], v2 offset:7168
    v_exp_f32 v48, v48
    v_cvt_pk_bf16_f32 v88, v40, v41
    v_cvt_pk_bf16_f32 v89, v42, v43
    v_cvt_pk_bf16_f32 v90, v44, v45
    v_cvt_pk_bf16_f32 v91, v46, v47
    v_exp_f32 v49, v49
    v_exp_f32 v50, v50
    v_mfma_f32_32x32x16_bf16 v[72:87], v[112:115], v[88:91], v[72:87]
    v_exp_f32 v51, v51
    v_exp_f32 v52, v52
    v_exp_f32 v53, v53
    v_exp_f32 v54, v54
    v_exp_f32 v55, v55
    s_nop 0
    v_cvt_pk_bf16_f32 v92, v48, v49
    v_cvt_pk_bf16_f32 v93, v50, v51
    v_cvt_pk_bf16_f32 v94, v52, v53
    v_cvt_pk_bf16_f32 v95, v54, v55
    s_nop 1
    v_mfma_f32_32x32x16_bf16 v[72:87], v[116:119], v[92:95], v[72:87]
    s_waitcnt lgkmcnt(0)
    v_exp_f32 v56, v56
    v_exp_f32 v57, v57
    v_exp_f32 v58, v58
    v_exp_f32 v59, v59
    v_mfma_f32_32x32x16_bf16 v[40:55], v[96:99], v[16:19], v[24:39]
    ds_read_b128 v[104:107], v2 offset:12288
    ds_read_b128 v[108:111], v2 offset:13312
    v_exp_f32 v60, v60
    v_exp_f32 v61, v61
    v_exp_f32 v62, v62
    v_exp_f32 v63, v63
    v_mfma_f32_32x32x16_bf16 v[40:55], v[100:103], v[20:23], v[40:55]
    ds_read_b128 v[112:115], v2 offset:10240
    ds_read_b128 v[116:119], v2 offset:11264
    v_exp_f32 v64, v64
    v_cvt_pk_bf16_f32 v88, v56, v57
    v_cvt_pk_bf16_f32 v89, v58, v59
    v_cvt_pk_bf16_f32 v90, v60, v61
    v_cvt_pk_bf16_f32 v91, v62, v63
    v_exp_f32 v65, v65
    v_exp_f32 v66, v66
    v_mfma_f32_32x32x16_bf16 v[72:87], v[120:123], v[88:91], v[72:87]
    v_exp_f32 v67, v67
    v_exp_f32 v68, v68
    v_exp_f32 v69, v69
    v_exp_f32 v70, v70
    v_exp_f32 v71, v71
    s_nop 0
    v_cvt_pk_bf16_f32 v92, v64, v65
    v_cvt_pk_bf16_f32 v93, v66, v67
    v_cvt_pk_bf16_f32 v94, v68, v69
    v_cvt_pk_bf16_f32 v95, v70, v71
    s_nop 1
    v_mfma_f32_32x32x16_bf16 v[72:87], v[124:127], v[92:95], v[72:87]
    s_waitcnt lgkmcnt(0)
    v_exp_f32 v40, v40
    v_exp_f32 v41, v41
    v_exp_f32 v42, v42
    v_exp_f32 v43, v43
    v_mfma_f32_32x32x16_bf16 v[56:71], v[104:107], v[16:19], v[24:39]
    ds_read_b128 v[96:99], v2 offset:16384
    ds_read_b128 v[100:103], v2 offset:17408
    v_exp_f32 v44, v44
    v_exp_f32 v45, v45
    v_exp_f32 v46, v46
    v_exp_f32 v47, v47
    v_mfma_f32_32x32x16_bf16 v[56:71], v[108:111], v[20:23], v[56:71]
    ds_read_b128 v[120:123], v2 offset:14336
    ds_read_b128 v[124:127], v2 offset:15360
    v_exp_f32 v48, v48
    v_cvt_pk_bf16_f32 v88, v40, v41
    v_cvt_pk_bf16_f32 v89, v42, v43
    v_cvt_pk_bf16_f32 v90, v44, v45
    v_cvt_pk_bf16_f32 v91, v46, v47
    v_exp_f32 v49, v49
    v_exp_f32 v50, v50
    v_mfma_f32_32x32x16_bf16 v[72:87], v[112:115], v[88:91], v[72:87]
    v_exp_f32 v51, v51
    v_exp_f32 v52, v52
    v_exp_f32 v53, v53
    v_exp_f32 v54, v54
    v_exp_f32 v55, v55
    s_nop 0
    v_cvt_pk_bf16_f32 v92, v48, v49
    v_cvt_pk_bf16_f32 v93, v50, v51
    v_cvt_pk_bf16_f32 v94, v52, v53
    v_cvt_pk_bf16_f32 v95, v54, v55
    s_nop 1
    v_mfma_f32_32x32x16_bf16 v[72:87], v[116:119], v[92:95], v[72:87]
    s_waitcnt lgkmcnt(0)
    v_exp_f32 v56, v56
    v_exp_f32 v57, v57
    v_exp_f32 v58, v58
    v_exp_f32 v59, v59
    v_mfma_f32_32x32x16_bf16 v[40:55], v[96:99], v[16:19], v[24:39]
    ds_read_b128 v[104:107], v2 offset:20480
    ds_read_b128 v[108:111], v2 offset:21504
    v_exp_f32 v60, v60
    v_exp_f32 v61, v61
    v_exp_f32 v62, v62
    v_exp_f32 v63, v63
    v_mfma_f32_32x32x16_bf16 v[40:55], v[100:103], v[20:23], v[40:55]
    ds_read_b128 v[112:115], v2 offset:18432
    ds_read_b128 v[116:119], v2 offset:19456
    v_exp_f32 v64, v64
    v_cvt_pk_bf16_f32 v88, v56, v57
    v_cvt_pk_bf16_f32 v89, v58, v59
    v_cvt_pk_bf16_f32 v90, v60, v61
    v_cvt_pk_bf16_f32 v91, v62, v63
    v_exp_f32 v65, v65
    v_exp_f32 v66, v66
    v_mfma_f32_32x32x16_bf16 v[72:87], v[120:123], v[88:91], v[72:87]
    v_exp_f32 v67, v67
    v_exp_f32 v68, v68
    v_exp_f32 v69, v69
    v_exp_f32 v70, v70
    v_exp_f32 v71, v71
    s_nop 0
    v_cvt_pk_bf16_f32 v92, v64, v65
    v_cvt_pk_bf16_f32 v93, v66, v67
    v_cvt_pk_bf16_f32 v94, v68, v69
    v_cvt_pk_bf16_f32 v95, v70, v71
    s_nop 1
    v_mfma_f32_32x32x16_bf16 v[72:87], v[124:127], v[92:95], v[72:87]
    s_waitcnt lgkmcnt(0)
    v_exp_f32 v40, v40
    v_exp_f32 v41, v41
    v_exp_f32 v42, v42
    v_exp_f32 v43, v43
    v_mfma_f32_32x32x16_bf16 v[56:71], v[104:107], v[16:19], v[24:39]
    ds_read_b128 v[96:99], v2 offset:24576
    ds_read_b128 v[100:103], v2 offset:25600
    v_exp_f32 v44, v44
    v_exp_f32 v45, v45
    v_exp_f32 v46, v46
    v_exp_f32 v47, v47
    v_mfma_f32_32x32x16_bf16 v[56:71], v[108:111], v[20:23], v[56:71]
    ds_read_b128 v[120:123], v2 offset:22528
    ds_read_b128 v[124:127], v2 offset:23552
    v_exp_f32 v48, v48
    v_cvt_pk_bf16_f32 v88, v40, v41
    v_cvt_pk_bf16_f32 v89, v42, v43
    v_cvt_pk_bf16_f32 v90, v44, v45
    v_cvt_pk_bf16_f32 v91, v46, v47
    v_exp_f32 v49, v49
    v_exp_f32 v50, v50
    v_mfma_f32_32x32x16_bf16 v[72:87], v[112:115], v[88:91], v[72:87]
    v_exp_f32 v51, v51
    v_exp_f32 v52, v52
    v_exp_f32 v53, v53
    v_exp_f32 v54, v54
    v_exp_f32 v55, v55
    s_nop 0
    v_cvt_pk_bf16_f32 v92, v48, v49
    v_cvt_pk_bf16_f32 v93, v50, v51
    v_cvt_pk_bf16_f32 v94, v52, v53
    v_cvt_pk_bf16_f32 v95, v54, v55
    s_nop 1
    v_mfma_f32_32x32x16_bf16 v[72:87], v[116:119], v[92:95], v[72:87]
    s_waitcnt lgkmcnt(0)
    v_exp_f32 v56, v56
    v_exp_f32 v57, v57
    v_exp_f32 v58, v58
    v_exp_f32 v59, v59
    v_mfma_f32_32x32x16_bf16 v[40:55], v[96:99], v[16:19], v[24:39]
    ds_read_b128 v[104:107], v2 offset:28672
    ds_read_b128 v[108:111], v2 offset:29696
    v_exp_f32 v60, v60
    v_exp_f32 v61, v61
    v_exp_f32 v62, v62
    v_exp_f32 v63, v63
    v_mfma_f32_32x32x16_bf16 v[40:55], v[100:103], v[20:23], v[40:55]
    ds_read_b128 v[112:115], v2 offset:26624
    ds_read_b128 v[116:119], v2 offset:27648
    v_exp_f32 v64, v64
    v_cvt_pk_bf16_f32 v88, v56, v57
    v_cvt_pk_bf16_f32 v89, v58, v59
    v_cvt_pk_bf16_f32 v90, v60, v61
    v_cvt_pk_bf16_f32 v91, v62, v63
    v_exp_f32 v65, v65
    v_exp_f32 v66, v66
    v_mfma_f32_32x32x16_bf16 v[72:87], v[120:123], v[88:91], v[72:87]
    v_exp_f32 v67, v67
    v_exp_f32 v68, v68
    v_exp_f32 v69, v69
    v_exp_f32 v70, v70
    v_exp_f32 v71, v71
    s_nop 0
    v_cvt_pk_bf16_f32 v92, v64, v65
    v_cvt_pk_bf16_f32 v93, v66, v67
    v_cvt_pk_bf16_f32 v94, v68, v69
    v_cvt_pk_bf16_f32 v95, v70, v71
    s_nop 1
    v_mfma_f32_32x32x16_bf16 v[72:87], v[124:127], v[92:95], v[72:87]
    s_waitcnt lgkmcnt(0)
    v_exp_f32 v40, v40
    v_exp_f32 v41, v41
    v_exp_f32 v42, v42
    v_exp_f32 v43, v43
    v_mfma_f32_32x32x16_bf16 v[56:71], v[104:107], v[16:19], v[24:39]
    v_exp_f32 v44, v44
    v_exp_f32 v45, v45
    v_exp_f32 v46, v46
    v_exp_f32 v47, v47
    v_mfma_f32_32x32x16_bf16 v[56:71], v[108:111], v[20:23], v[56:71]
    ds_read_b128 v[120:123], v2 offset:30720
    ds_read_b128 v[124:127], v2 offset:31744
    v_exp_f32 v48, v48
    v_cvt_pk_bf16_f32 v88, v40, v41
    v_cvt_pk_bf16_f32 v89, v42, v43
    v_cvt_pk_bf16_f32 v90, v44, v45
    v_cvt_pk_bf16_f32 v91, v46, v47
    v_exp_f32 v49, v49
    v_exp_f32 v50, v50
    v_mfma_f32_32x32x16_bf16 v[72:87], v[112:115], v[88:91], v[72:87]
    v_exp_f32 v51, v51
    v_exp_f32 v52, v52
    v_exp_f32 v53, v53
    v_exp_f32 v54, v54
    v_exp_f32 v55, v55
    s_nop 0
    v_cvt_pk_bf16_f32 v92, v48, v49
    v_cvt_pk_bf16_f32 v93, v50, v51
    v_cvt_pk_bf16_f32 v94, v52, v53
    v_cvt_pk_bf16_f32 v95, v54, v55
    s_nop 1
    v_mfma_f32_32x32x16_bf16 v[72:87], v[116:119], v[92:95], v[72:87]
    s_waitcnt lgkmcnt(0)
    v_exp_f32 v56, v56
    v_exp_f32 v57, v57
    v_exp_f32 v58, v58
    v_exp_f32 v59, v59
    v_exp_f32 v60, v60
    v_exp_f32 v61, v61
    v_exp_f32 v62, v62
    v_exp_f32 v63, v63
    v_exp_f32 v64, v64
    v_cvt_pk_bf16_f32 v88, v56, v57
    v_cvt_pk_bf16_f32 v89, v58, v59
    v_cvt_pk_bf16_f32 v90, v60, v61
    v_cvt_pk_bf16_f32 v91, v62, v63
    v_exp_f32 v65, v65
    v_exp_f32 v66, v66
    v_mfma_f32_32x32x16_bf16 v[72:87], v[120:123], v[88:91], v[72:87]
    v_exp_f32 v67, v67
    v_exp_f32 v68, v68
    v_exp_f32 v69, v69
    v_exp_f32 v70, v70
    v_exp_f32 v71, v71
    s_nop 0
    v_cvt_pk_bf16_f32 v92, v64, v65
    v_cvt_pk_bf16_f32 v93, v66, v67
    v_cvt_pk_bf16_f32 v94, v68, v69
    v_cvt_pk_bf16_f32 v95, v70, v71
    s_nop 1
    v_mfma_f32_32x32x16_bf16 v[72:87], v[124:127], v[92:95], v[72:87]
K2_EPI:
    s_nop 7
    s_nop 7
    v_mov_b32 v4, v84
    v_mov_b32 v5, v84
    s_nop 1
    v_permlane32_swap_b32 v4, v5
    v_rcp_f32 v5, v5
    v_lshrrev_b32 v6, 9, v1
    v_cmp_eq_u32 vcc, 1, v6
    v_mul_f32 v72, v5, v72
    v_mul_f32 v73, v5, v73
    v_mul_f32 v74, v5, v74
    v_mul_f32 v75, v5, v75
    v_mul_f32 v76, v5, v76
    v_mul_f32 v77, v5, v77
    v_mul_f32 v78, v5, v78
    v_mul_f32 v79, v5, v79
    v_mul_f32 v80, v5, v80
    v_mul_f32 v81, v5, v81
    v_mul_f32 v82, v5, v82
    v_mul_f32 v83, v5, v83
    v_mul_f32 v84, v5, v84
    v_mul_f32 v85, v5, v85
    v_mul_f32 v86, v5, v86
    v_mul_f32 v87, v5, v87
    v_mov_b32 v7, 0
    v_cndmask_b32 v84, v84, v7, vcc
    v_cndmask_b32 v85, v85, v7, vcc
    v_cndmask_b32 v86, v86, v7, vcc
    v_cndmask_b32 v87, v87, v7, vcc
    v_cvt_pk_bf16_f32 v88, v72, v73
    v_cvt_pk_bf16_f32 v89, v74, v75
    v_cvt_pk_bf16_f32 v90, v76, v77
    v_cvt_pk_bf16_f32 v91, v78, v79
    v_cvt_pk_bf16_f32 v92, v80, v81
    v_cvt_pk_bf16_f32 v93, v82, v83
    v_cvt_pk_bf16_f32 v94, v84, v85
    v_cvt_pk_bf16_f32 v95, v86, v87
    s_lshl_b32 s34, s33, 4
    s_add_u32 s34, s34, s31
    s_lshl_b32 s34, s34, 11
    s_add_u32 s34, s34, 2359296
    buffer_store_dwordx4 v[88:91], v1, s[8:11], s34 offen
    buffer_store_dwordx4 v[92:95], v1, s[8:11], s34 offen offset:1024
    s_endpgm
K2_LOADER:
    s_load_dwordx2 s[12:13], s[0:1], 32
    s_load_dwordx2 s[14:15], s[0:1], 48
    s_load_dwordx2 s[16:17], s[0:1], 64
    s_barrier
    s_mov_b32 m0, 32768
    s_mov_b32 s40, 2129920
    buffer_load_dwordx4 v1, s[8:11], s40 offen offset:0 lds
    buffer_load_dwordx4 v1, s[8:11], s40 offen offset:1024 lds
    buffer_load_dwordx4 v1, s[8:11], s40 offen offset:2048 lds
    buffer_load_dwordx4 v1, s[8:11], s40 offen offset:3072 lds
    s_mov_b32 m0, 36864
    s_mov_b32 s40, 2134016
    buffer_load_dwordx4 v1, s[8:11], s40 offen offset:0 lds
    buffer_load_dwordx4 v1, s[8:11], s40 offen offset:1024 lds
    buffer_load_dwordx4 v1, s[8:11], s40 offen offset:2048 lds
    buffer_load_dwordx4 v1, s[8:11], s40 offen offset:3072 lds
    s_mov_b32 m0, 40960
    s_mov_b32 s40, 2138112
    buffer_load_dwordx4 v1, s[8:11], s40 offen offset:0 lds
    buffer_load_dwordx4 v1, s[8:11], s40 offen offset:1024 lds
    buffer_load_dwordx4 v1, s[8:11], s40 offen offset:2048 lds
    buffer_load_dwordx4 v1, s[8:11], s40 offen offset:3072 lds
    s_mov_b32 m0, 45056
    s_mov_b32 s40, 2142208
    buffer_load_dwordx4 v1, s[8:11], s40 offen offset:0 lds
    buffer_load_dwordx4 v1, s[8:11], s40 offen offset:1024 lds
    buffer_load_dwordx4 v1, s[8:11], s40 offen offset:2048 lds
    buffer_load_dwordx4 v1, s[8:11], s40 offen offset:3072 lds
    s_mov_b32 m0, 49152
    s_mov_b32 s40, 2146304
    buffer_load_dwordx4 v1, s[8:11], s40 offen offset:0 lds
    buffer_load_dwordx4 v1, s[8:11], s40 offen offset:1024 lds
    buffer_load_dwordx4 v1, s[8:11], s40 offen offset:2048 lds
    buffer_load_dwordx4 v1, s[8:11], s40 offen offset:3072 lds
    s_mov_b32 m0, 53248
    s_mov_b32 s40, 2150400
    buffer_load_dwordx4 v1, s[8:11], s40 offen offset:0 lds
    buffer_load_dwordx4 v1, s[8:11], s40 offen offset:1024 lds
    buffer_load_dwordx4 v1, s[8:11], s40 offen offset:2048 lds
    buffer_load_dwordx4 v1, s[8:11], s40 offen offset:3072 lds
    s_mov_b32 m0, 57344
    s_mov_b32 s40, 2154496
    buffer_load_dwordx4 v1, s[8:11], s40 offen offset:0 lds
    buffer_load_dwordx4 v1, s[8:11], s40 offen offset:1024 lds
    buffer_load_dwordx4 v1, s[8:11], s40 offen offset:2048 lds
    buffer_load_dwordx4 v1, s[8:11], s40 offen offset:3072 lds
    s_mov_b32 m0, 61440
    s_mov_b32 s40, 2158592
    buffer_load_dwordx4 v1, s[8:11], s40 offen offset:0 lds
    buffer_load_dwordx4 v1, s[8:11], s40 offen offset:1024 lds
    buffer_load_dwordx4 v1, s[8:11], s40 offen offset:2048 lds
    buffer_load_dwordx4 v1, s[8:11], s40 offen offset:3072 lds
    s_waitcnt lgkmcnt(0)
    s_mov_b32 s20, s12
    s_and_b32 s21, s13, 0xffff
    s_mov_b32 s22, 401408
    s_mov_b32 s23, 0x00020000
    s_mov_b32 s24, s14
    s_and_b32 s25, s15, 0xffff
    s_mov_b32 s26, 7340032
    s_mov_b32 s27, 0x00020000
    s_mov_b32 s28, s16
    s_and_b32 s29, s17, 0xffff
    s_mov_b32 s30, 7340032
    s_mov_b32 s31, 0x00020000
    s_lshl_b32 s46, s2, 11
    s_mul_i32 s47, s2, 28672
    s_mov_b32 m0, 65536
    s_mov_b32 s40, 2162688
    buffer_load_dwordx4 v1, s[8:11], s40 offen offset:0 lds
    buffer_load_dwordx4 v1, s[8:11], s40 offen offset:1024 lds
    buffer_load_dwordx4 v1, s[8:11], s40 offen offset:2048 lds
    buffer_load_dwordx4 v1, s[8:11], s40 offen offset:3072 lds
    s_mov_b32 m0, 69632
    s_mov_b32 s40, 2166784
    buffer_load_dwordx4 v1, s[8:11], s40 offen offset:0 lds
    buffer_load_dwordx4 v1, s[8:11], s40 offen offset:1024 lds
    buffer_load_dwordx4 v1, s[8:11], s40 offen offset:2048 lds
    buffer_load_dwordx4 v1, s[8:11], s40 offen offset:3072 lds
    s_mov_b32 m0, 73728
    s_mov_b32 s40, 2170880
    buffer_load_dwordx4 v1, s[8:11], s40 offen offset:0 lds
    buffer_load_dwordx4 v1, s[8:11], s40 offen offset:1024 lds
    buffer_load_dwordx4 v1, s[8:11], s40 offen offset:2048 lds
    buffer_load_dwordx4 v1, s[8:11], s40 offen offset:3072 lds
    s_mov_b32 m0, 77824
    s_mov_b32 s40, 2174976
    buffer_load_dwordx4 v1, s[8:11], s40 offen offset:0 lds
    buffer_load_dwordx4 v1, s[8:11], s40 offen offset:1024 lds
    buffer_load_dwordx4 v1, s[8:11], s40 offen offset:2048 lds
    buffer_load_dwordx4 v1, s[8:11], s40 offen offset:3072 lds
    s_mov_b32 m0, 81920
    s_mov_b32 s40, 2179072
    buffer_load_dwordx4 v1, s[8:11], s40 offen offset:0 lds
    buffer_load_dwordx4 v1, s[8:11], s40 offen offset:1024 lds
    buffer_load_dwordx4 v1, s[8:11], s40 offen offset:2048 lds
    buffer_load_dwordx4 v1, s[8:11], s40 offen offset:3072 lds
    s_mov_b32 m0, 86016
    s_mov_b32 s40, 2183168
    buffer_load_dwordx4 v1, s[8:11], s40 offen offset:0 lds
    buffer_load_dwordx4 v1, s[8:11], s40 offen offset:1024 lds
    buffer_load_dwordx4 v1, s[8:11], s40 offen offset:2048 lds
    buffer_load_dwordx4 v1, s[8:11], s40 offen offset:3072 lds
    s_mov_b32 m0, 90112
    s_mov_b32 s40, 2187264
    buffer_load_dwordx4 v1, s[8:11], s40 offen offset:0 lds
    buffer_load_dwordx4 v1, s[8:11], s40 offen offset:1024 lds
    buffer_load_dwordx4 v1, s[8:11], s40 offen offset:2048 lds
    buffer_load_dwordx4 v1, s[8:11], s40 offen offset:3072 lds
    s_mov_b32 m0, 94208
    s_mov_b32 s40, 2191360
    buffer_load_dwordx4 v1, s[8:11], s40 offen offset:0 lds
    buffer_load_dwordx4 v1, s[8:11], s40 offen offset:1024 lds
    buffer_load_dwordx4 v1, s[8:11], s40 offen offset:2048 lds
    buffer_load_dwordx4 v1, s[8:11], s40 offen offset:3072 lds
    s_waitcnt vmcnt(32)
    s_barrier
    s_mov_b32 m0, 98304
    s_mov_b32 s40, 2195456
    buffer_load_dwordx4 v1, s[8:11], s40 offen offset:0 lds
    buffer_load_dwordx4 v1, s[8:11], s40 offen offset:1024 lds
    buffer_load_dwordx4 v1, s[8:11], s40 offen offset:2048 lds
    buffer_load_dwordx4 v1, s[8:11], s40 offen offset:3072 lds
    s_mov_b32 m0, 102400
    s_mov_b32 s40, 2199552
    buffer_load_dwordx4 v1, s[8:11], s40 offen offset:0 lds
    buffer_load_dwordx4 v1, s[8:11], s40 offen offset:1024 lds
    buffer_load_dwordx4 v1, s[8:11], s40 offen offset:2048 lds
    buffer_load_dwordx4 v1, s[8:11], s40 offen offset:3072 lds
    s_mov_b32 m0, 106496
    s_mov_b32 s40, 2203648
    buffer_load_dwordx4 v1, s[8:11], s40 offen offset:0 lds
    buffer_load_dwordx4 v1, s[8:11], s40 offen offset:1024 lds
    buffer_load_dwordx4 v1, s[8:11], s40 offen offset:2048 lds
    buffer_load_dwordx4 v1, s[8:11], s40 offen offset:3072 lds
    s_mov_b32 m0, 110592
    s_mov_b32 s40, 2207744
    buffer_load_dwordx4 v1, s[8:11], s40 offen offset:0 lds
    buffer_load_dwordx4 v1, s[8:11], s40 offen offset:1024 lds
    buffer_load_dwordx4 v1, s[8:11], s40 offen offset:2048 lds
    buffer_load_dwordx4 v1, s[8:11], s40 offen offset:3072 lds
    s_mov_b32 m0, 114688
    s_mov_b32 s40, 2211840
    buffer_load_dwordx4 v1, s[8:11], s40 offen offset:0 lds
    buffer_load_dwordx4 v1, s[8:11], s40 offen offset:1024 lds
    buffer_load_dwordx4 v1, s[8:11], s40 offen offset:2048 lds
    buffer_load_dwordx4 v1, s[8:11], s40 offen offset:3072 lds
    s_mov_b32 m0, 118784
    s_mov_b32 s40, 2215936
    buffer_load_dwordx4 v1, s[8:11], s40 offen offset:0 lds
    buffer_load_dwordx4 v1, s[8:11], s40 offen offset:1024 lds
    buffer_load_dwordx4 v1, s[8:11], s40 offen offset:2048 lds
    buffer_load_dwordx4 v1, s[8:11], s40 offen offset:3072 lds
    s_mov_b32 m0, 122880
    s_mov_b32 s40, 2220032
    buffer_load_dwordx4 v1, s[8:11], s40 offen offset:0 lds
    buffer_load_dwordx4 v1, s[8:11], s40 offen offset:1024 lds
    buffer_load_dwordx4 v1, s[8:11], s40 offen offset:2048 lds
    buffer_load_dwordx4 v1, s[8:11], s40 offen offset:3072 lds
    s_mov_b32 m0, 126976
    s_mov_b32 s40, 2224128
    buffer_load_dwordx4 v1, s[8:11], s40 offen offset:0 lds
    buffer_load_dwordx4 v1, s[8:11], s40 offen offset:1024 lds
    buffer_load_dwordx4 v1, s[8:11], s40 offen offset:2048 lds
    buffer_load_dwordx4 v1, s[8:11], s40 offen offset:3072 lds
    buffer_load_dwordx4 v[8:11], v1, s[20:23], s46 offen offset:0
    buffer_load_dwordx4 v[8:11], v1, s[20:23], s46 offen offset:1024
    buffer_load_dwordx4 v[8:11], v1, s[24:27], s47 offen offset:0
    buffer_load_dwordx4 v[8:11], v1, s[24:27], s47 offen offset:1024
    buffer_load_dwordx4 v[8:11], v1, s[24:27], s47 offen offset:2048
    buffer_load_dwordx4 v[8:11], v1, s[24:27], s47 offen offset:3072
    s_add_u32 s48, s47, 4096
    buffer_load_dwordx4 v[8:11], v1, s[24:27], s48 offen offset:0
    s_add_u32 s48, s47, 4096
    buffer_load_dwordx4 v[8:11], v1, s[24:27], s48 offen offset:1024
    s_add_u32 s48, s47, 4096
    buffer_load_dwordx4 v[8:11], v1, s[24:27], s48 offen offset:2048
    s_waitcnt vmcnt(41)
    s_barrier
    s_mov_b32 m0, 0
    s_mov_b32 s40, 2228224
    buffer_load_dwordx4 v1, s[8:11], s40 offen offset:0 lds
    buffer_load_dwordx4 v1, s[8:11], s40 offen offset:1024 lds
    buffer_load_dwordx4 v1, s[8:11], s40 offen offset:2048 lds
    buffer_load_dwordx4 v1, s[8:11], s40 offen offset:3072 lds
    s_mov_b32 m0, 4096
    s_mov_b32 s40, 2232320
    buffer_load_dwordx4 v1, s[8:11], s40 offen offset:0 lds
    buffer_load_dwordx4 v1, s[8:11], s40 offen offset:1024 lds
    buffer_load_dwordx4 v1, s[8:11], s40 offen offset:2048 lds
    buffer_load_dwordx4 v1, s[8:11], s40 offen offset:3072 lds
    s_mov_b32 m0, 8192
    s_mov_b32 s40, 2236416
    buffer_load_dwordx4 v1, s[8:11], s40 offen offset:0 lds
    buffer_load_dwordx4 v1, s[8:11], s40 offen offset:1024 lds
    buffer_load_dwordx4 v1, s[8:11], s40 offen offset:2048 lds
    buffer_load_dwordx4 v1, s[8:11], s40 offen offset:3072 lds
    s_mov_b32 m0, 12288
    s_mov_b32 s40, 2240512
    buffer_load_dwordx4 v1, s[8:11], s40 offen offset:0 lds
    buffer_load_dwordx4 v1, s[8:11], s40 offen offset:1024 lds
    buffer_load_dwordx4 v1, s[8:11], s40 offen offset:2048 lds
    buffer_load_dwordx4 v1, s[8:11], s40 offen offset:3072 lds
    s_mov_b32 m0, 16384
    s_mov_b32 s40, 2244608
    buffer_load_dwordx4 v1, s[8:11], s40 offen offset:0 lds
    buffer_load_dwordx4 v1, s[8:11], s40 offen offset:1024 lds
    buffer_load_dwordx4 v1, s[8:11], s40 offen offset:2048 lds
    buffer_load_dwordx4 v1, s[8:11], s40 offen offset:3072 lds
    s_mov_b32 m0, 20480
    s_mov_b32 s40, 2248704
    buffer_load_dwordx4 v1, s[8:11], s40 offen offset:0 lds
    buffer_load_dwordx4 v1, s[8:11], s40 offen offset:1024 lds
    buffer_load_dwordx4 v1, s[8:11], s40 offen offset:2048 lds
    buffer_load_dwordx4 v1, s[8:11], s40 offen offset:3072 lds
    s_mov_b32 m0, 24576
    s_mov_b32 s40, 2252800
    buffer_load_dwordx4 v1, s[8:11], s40 offen offset:0 lds
    buffer_load_dwordx4 v1, s[8:11], s40 offen offset:1024 lds
    buffer_load_dwordx4 v1, s[8:11], s40 offen offset:2048 lds
    buffer_load_dwordx4 v1, s[8:11], s40 offen offset:3072 lds
    s_mov_b32 m0, 28672
    s_mov_b32 s40, 2256896
    buffer_load_dwordx4 v1, s[8:11], s40 offen offset:0 lds
    buffer_load_dwordx4 v1, s[8:11], s40 offen offset:1024 lds
    buffer_load_dwordx4 v1, s[8:11], s40 offen offset:2048 lds
    buffer_load_dwordx4 v1, s[8:11], s40 offen offset:3072 lds
    s_add_u32 s48, s47, 4096
    buffer_load_dwordx4 v[8:11], v1, s[24:27], s48 offen offset:3072
    s_add_u32 s48, s47, 8192
    buffer_load_dwordx4 v[8:11], v1, s[24:27], s48 offen offset:0
    s_add_u32 s48, s47, 8192
    buffer_load_dwordx4 v[8:11], v1, s[24:27], s48 offen offset:1024
    s_add_u32 s48, s47, 8192
    buffer_load_dwordx4 v[8:11], v1, s[24:27], s48 offen offset:2048
    s_add_u32 s48, s47, 8192
    buffer_load_dwordx4 v[8:11], v1, s[24:27], s48 offen offset:3072
    s_add_u32 s48, s47, 12288
    buffer_load_dwordx4 v[8:11], v1, s[24:27], s48 offen offset:0
    s_add_u32 s48, s47, 12288
    buffer_load_dwordx4 v[8:11], v1, s[24:27], s48 offen offset:1024
    s_add_u32 s48, s47, 12288
    buffer_load_dwordx4 v[8:11], v1, s[24:27], s48 offen offset:2048
    s_add_u32 s48, s47, 12288
    buffer_load_dwordx4 v[8:11], v1, s[24:27], s48 offen offset:3072
    s_waitcnt vmcnt(50)
    s_barrier
    s_mov_b32 m0, 32768
    s_mov_b32 s40, 2260992
    buffer_load_dwordx4 v1, s[8:11], s40 offen offset:0 lds
    buffer_load_dwordx4 v1, s[8:11], s40 offen offset:1024 lds
    buffer_load_dwordx4 v1, s[8:11], s40 offen offset:2048 lds
    buffer_load_dwordx4 v1, s[8:11], s40 offen offset:3072 lds
    s_mov_b32 m0, 36864
    s_mov_b32 s40, 2265088
    buffer_load_dwordx4 v1, s[8:11], s40 offen offset:0 lds
    buffer_load_dwordx4 v1, s[8:11], s40 offen offset:1024 lds
    buffer_load_dwordx4 v1, s[8:11], s40 offen offset:2048 lds
    buffer_load_dwordx4 v1, s[8:11], s40 offen offset:3072 lds
    s_mov_b32 m0, 40960
    s_mov_b32 s40, 2269184
    buffer_load_dwordx4 v1, s[8:11], s40 offen offset:0 lds
    buffer_load_dwordx4 v1, s[8:11], s40 offen offset:1024 lds
    buffer_load_dwordx4 v1, s[8:11], s40 offen offset:2048 lds
    buffer_load_dwordx4 v1, s[8:11], s40 offen offset:3072 lds
    s_mov_b32 m0, 45056
    s_mov_b32 s40, 2273280
    buffer_load_dwordx4 v1, s[8:11], s40 offen offset:0 lds
    buffer_load_dwordx4 v1, s[8:11], s40 offen offset:1024 lds
    buffer_load_dwordx4 v1, s[8:11], s40 offen offset:2048 lds
    buffer_load_dwordx4 v1, s[8:11], s40 offen offset:3072 lds
    s_mov_b32 m0, 49152
    s_mov_b32 s40, 2277376
    buffer_load_dwordx4 v1, s[8:11], s40 offen offset:0 lds
    buffer_load_dwordx4 v1, s[8:11], s40 offen offset:1024 lds
    buffer_load_dwordx4 v1, s[8:11], s40 offen offset:2048 lds
    buffer_load_dwordx4 v1, s[8:11], s40 offen offset:3072 lds
    s_mov_b32 m0, 53248
    s_mov_b32 s40, 2281472
    buffer_load_dwordx4 v1, s[8:11], s40 offen offset:0 lds
    buffer_load_dwordx4 v1, s[8:11], s40 offen offset:1024 lds
    buffer_load_dwordx4 v1, s[8:11], s40 offen offset:2048 lds
    buffer_load_dwordx4 v1, s[8:11], s40 offen offset:3072 lds
    s_mov_b32 m0, 57344
    s_mov_b32 s40, 2285568
    buffer_load_dwordx4 v1, s[8:11], s40 offen offset:0 lds
    buffer_load_dwordx4 v1, s[8:11], s40 offen offset:1024 lds
    buffer_load_dwordx4 v1, s[8:11], s40 offen offset:2048 lds
    buffer_load_dwordx4 v1, s[8:11], s40 offen offset:3072 lds
    s_mov_b32 m0, 61440
    s_mov_b32 s40, 2289664
    buffer_load_dwordx4 v1, s[8:11], s40 offen offset:0 lds
    buffer_load_dwordx4 v1, s[8:11], s40 offen offset:1024 lds
    buffer_load_dwordx4 v1, s[8:11], s40 offen offset:2048 lds
    buffer_load_dwordx4 v1, s[8:11], s40 offen offset:3072 lds
    s_add_u32 s48, s47, 16384
    buffer_load_dwordx4 v[8:11], v1, s[24:27], s48 offen offset:0
    s_add_u32 s48, s47, 16384
    buffer_load_dwordx4 v[8:11], v1, s[24:27], s48 offen offset:1024
    s_add_u32 s48, s47, 16384
    buffer_load_dwordx4 v[8:11], v1, s[24:27], s48 offen offset:2048
    s_add_u32 s48, s47, 16384
    buffer_load_dwordx4 v[8:11], v1, s[24:27], s48 offen offset:3072
    s_add_u32 s48, s47, 20480
    buffer_load_dwordx4 v[8:11], v1, s[24:27], s48 offen offset:0
    s_add_u32 s48, s47, 20480
    buffer_load_dwordx4 v[8:11], v1, s[24:27], s48 offen offset:1024
    s_add_u32 s48, s47, 20480
    buffer_load_dwordx4 v[8:11], v1, s[24:27], s48 offen offset:2048
    s_add_u32 s48, s47, 20480
    buffer_load_dwordx4 v[8:11], v1, s[24:27], s48 offen offset:3072
    s_add_u32 s48, s47, 24576
    buffer_load_dwordx4 v[8:11], v1, s[24:27], s48 offen offset:0
    s_waitcnt vmcnt(50)
    s_barrier
    s_mov_b32 m0, 65536
    s_mov_b32 s40, 2293760
    buffer_load_dwordx4 v1, s[8:11], s40 offen offset:0 lds
    buffer_load_dwordx4 v1, s[8:11], s40 offen offset:1024 lds
    buffer_load_dwordx4 v1, s[8:11], s40 offen offset:2048 lds
    buffer_load_dwordx4 v1, s[8:11], s40 offen offset:3072 lds
    s_mov_b32 m0, 69632
    s_mov_b32 s40, 2297856
    buffer_load_dwordx4 v1, s[8:11], s40 offen offset:0 lds
    buffer_load_dwordx4 v1, s[8:11], s40 offen offset:1024 lds
    buffer_load_dwordx4 v1, s[8:11], s40 offen offset:2048 lds
    buffer_load_dwordx4 v1, s[8:11], s40 offen offset:3072 lds
    s_mov_b32 m0, 73728
    s_mov_b32 s40, 2301952
    buffer_load_dwordx4 v1, s[8:11], s40 offen offset:0 lds
    buffer_load_dwordx4 v1, s[8:11], s40 offen offset:1024 lds
    buffer_load_dwordx4 v1, s[8:11], s40 offen offset:2048 lds
    buffer_load_dwordx4 v1, s[8:11], s40 offen offset:3072 lds
    s_mov_b32 m0, 77824
    s_mov_b32 s40, 2306048
    buffer_load_dwordx4 v1, s[8:11], s40 offen offset:0 lds
    buffer_load_dwordx4 v1, s[8:11], s40 offen offset:1024 lds
    buffer_load_dwordx4 v1, s[8:11], s40 offen offset:2048 lds
    buffer_load_dwordx4 v1, s[8:11], s40 offen offset:3072 lds
    s_mov_b32 m0, 81920
    s_mov_b32 s40, 2310144
    buffer_load_dwordx4 v1, s[8:11], s40 offen offset:0 lds
    buffer_load_dwordx4 v1, s[8:11], s40 offen offset:1024 lds
    buffer_load_dwordx4 v1, s[8:11], s40 offen offset:2048 lds
    buffer_load_dwordx4 v1, s[8:11], s40 offen offset:3072 lds
    s_mov_b32 m0, 86016
    s_mov_b32 s40, 2314240
    buffer_load_dwordx4 v1, s[8:11], s40 offen offset:0 lds
    buffer_load_dwordx4 v1, s[8:11], s40 offen offset:1024 lds
    buffer_load_dwordx4 v1, s[8:11], s40 offen offset:2048 lds
    buffer_load_dwordx4 v1, s[8:11], s40 offen offset:3072 lds
    s_mov_b32 m0, 90112
    s_mov_b32 s40, 2318336
    buffer_load_dwordx4 v1, s[8:11], s40 offen offset:0 lds
    buffer_load_dwordx4 v1, s[8:11], s40 offen offset:1024 lds
    buffer_load_dwordx4 v1, s[8:11], s40 offen offset:2048 lds
    buffer_load_dwordx4 v1, s[8:11], s40 offen offset:3072 lds
    s_mov_b32 m0, 94208
    s_mov_b32 s40, 2322432
    buffer_load_dwordx4 v1, s[8:11], s40 offen offset:0 lds
    buffer_load_dwordx4 v1, s[8:11], s40 offen offset:1024 lds
    buffer_load_dwordx4 v1, s[8:11], s40 offen offset:2048 lds
    buffer_load_dwordx4 v1, s[8:11], s40 offen offset:3072 lds
    s_add_u32 s48, s47, 24576
    buffer_load_dwordx4 v[8:11], v1, s[24:27], s48 offen offset:1024
    s_add_u32 s48, s47, 24576
    buffer_load_dwordx4 v[8:11], v1, s[24:27], s48 offen offset:2048
    s_add_u32 s48, s47, 24576
    buffer_load_dwordx4 v[8:11], v1, s[24:27], s48 offen offset:3072
    buffer_load_dwordx4 v[8:11], v1, s[28:31], s47 offen offset:0
    buffer_load_dwordx4 v[8:11], v1, s[28:31], s47 offen offset:1024
    buffer_load_dwordx4 v[8:11], v1, s[28:31], s47 offen offset:2048
    buffer_load_dwordx4 v[8:11], v1, s[28:31], s47 offen offset:3072
    s_add_u32 s48, s47, 4096
    buffer_load_dwordx4 v[8:11], v1, s[28:31], s48 offen offset:0
    s_add_u32 s48, s47, 4096
    buffer_load_dwordx4 v[8:11], v1, s[28:31], s48 offen offset:1024
    s_waitcnt vmcnt(50)
    s_barrier
    s_mov_b32 m0, 98304
    s_mov_b32 s40, 2326528
    buffer_load_dwordx4 v1, s[8:11], s40 offen offset:0 lds
    buffer_load_dwordx4 v1, s[8:11], s40 offen offset:1024 lds
    buffer_load_dwordx4 v1, s[8:11], s40 offen offset:2048 lds
    buffer_load_dwordx4 v1, s[8:11], s40 offen offset:3072 lds
    s_mov_b32 m0, 102400
    s_mov_b32 s40, 2330624
    buffer_load_dwordx4 v1, s[8:11], s40 offen offset:0 lds
    buffer_load_dwordx4 v1, s[8:11], s40 offen offset:1024 lds
    buffer_load_dwordx4 v1, s[8:11], s40 offen offset:2048 lds
    buffer_load_dwordx4 v1, s[8:11], s40 offen offset:3072 lds
    s_mov_b32 m0, 106496
    s_mov_b32 s40, 2334720
    buffer_load_dwordx4 v1, s[8:11], s40 offen offset:0 lds
    buffer_load_dwordx4 v1, s[8:11], s40 offen offset:1024 lds
    buffer_load_dwordx4 v1, s[8:11], s40 offen offset:2048 lds
    buffer_load_dwordx4 v1, s[8:11], s40 offen offset:3072 lds
    s_mov_b32 m0, 110592
    s_mov_b32 s40, 2338816
    buffer_load_dwordx4 v1, s[8:11], s40 offen offset:0 lds
    buffer_load_dwordx4 v1, s[8:11], s40 offen offset:1024 lds
    buffer_load_dwordx4 v1, s[8:11], s40 offen offset:2048 lds
    buffer_load_dwordx4 v1, s[8:11], s40 offen offset:3072 lds
    s_mov_b32 m0, 114688
    s_mov_b32 s40, 2342912
    buffer_load_dwordx4 v1, s[8:11], s40 offen offset:0 lds
    buffer_load_dwordx4 v1, s[8:11], s40 offen offset:1024 lds
    buffer_load_dwordx4 v1, s[8:11], s40 offen offset:2048 lds
    buffer_load_dwordx4 v1, s[8:11], s40 offen offset:3072 lds
    s_mov_b32 m0, 118784
    s_mov_b32 s40, 2347008
    buffer_load_dwordx4 v1, s[8:11], s40 offen offset:0 lds
    buffer_load_dwordx4 v1, s[8:11], s40 offen offset:1024 lds
    buffer_load_dwordx4 v1, s[8:11], s40 offen offset:2048 lds
    buffer_load_dwordx4 v1, s[8:11], s40 offen offset:3072 lds
    s_mov_b32 m0, 122880
    s_mov_b32 s40, 2351104
    buffer_load_dwordx4 v1, s[8:11], s40 offen offset:0 lds
    buffer_load_dwordx4 v1, s[8:11], s40 offen offset:1024 lds
    buffer_load_dwordx4 v1, s[8:11], s40 offen offset:2048 lds
    buffer_load_dwordx4 v1, s[8:11], s40 offen offset:3072 lds
    s_mov_b32 m0, 126976
    s_mov_b32 s40, 2355200
    buffer_load_dwordx4 v1, s[8:11], s40 offen offset:0 lds
    buffer_load_dwordx4 v1, s[8:11], s40 offen offset:1024 lds
    buffer_load_dwordx4 v1, s[8:11], s40 offen offset:2048 lds
    buffer_load_dwordx4 v1, s[8:11], s40 offen offset:3072 lds
    s_add_u32 s48, s47, 4096
    buffer_load_dwordx4 v[8:11], v1, s[28:31], s48 offen offset:2048
    s_add_u32 s48, s47, 4096
    buffer_load_dwordx4 v[8:11], v1, s[28:31], s48 offen offset:3072
    s_add_u32 s48, s47, 8192
    buffer_load_dwordx4 v[8:11], v1, s[28:31], s48 offen offset:0
    s_add_u32 s48, s47, 8192
    buffer_load_dwordx4 v[8:11], v1, s[28:31], s48 offen offset:1024
    s_add_u32 s48, s47, 8192
    buffer_load_dwordx4 v[8:11], v1, s[28:31], s48 offen offset:2048
    s_add_u32 s48, s47, 8192
    buffer_load_dwordx4 v[8:11], v1, s[28:31], s48 offen offset:3072
    s_add_u32 s48, s47, 12288
    buffer_load_dwordx4 v[8:11], v1, s[28:31], s48 offen offset:0
    s_add_u32 s48, s47, 12288
    buffer_load_dwordx4 v[8:11], v1, s[28:31], s48 offen offset:1024
    s_add_u32 s48, s47, 12288
    buffer_load_dwordx4 v[8:11], v1, s[28:31], s48 offen offset:2048
    s_waitcnt vmcnt(50)
    s_barrier
    s_add_u32 s48, s47, 12288
    buffer_load_dwordx4 v[8:11], v1, s[28:31], s48 offen offset:3072
    s_add_u32 s48, s47, 16384
    buffer_load_dwordx4 v[8:11], v1, s[28:31], s48 offen offset:0
    s_add_u32 s48, s47, 16384
    buffer_load_dwordx4 v[8:11], v1, s[28:31], s48 offen offset:1024
    s_add_u32 s48, s47, 16384
    buffer_load_dwordx4 v[8:11], v1, s[28:31], s48 offen offset:2048
    s_add_u32 s48, s47, 16384
    buffer_load_dwordx4 v[8:11], v1, s[28:31], s48 offen offset:3072
    s_add_u32 s48, s47, 20480
    buffer_load_dwordx4 v[8:11], v1, s[28:31], s48 offen offset:0
    s_add_u32 s48, s47, 20480
    buffer_load_dwordx4 v[8:11], v1, s[28:31], s48 offen offset:1024
    s_add_u32 s48, s47, 20480
    buffer_load_dwordx4 v[8:11], v1, s[28:31], s48 offen offset:2048
    s_add_u32 s48, s47, 20480
    buffer_load_dwordx4 v[8:11], v1, s[28:31], s48 offen offset:3072
    s_waitcnt vmcnt(18)
    s_barrier
    s_add_u32 s48, s47, 24576
    buffer_load_dwordx4 v[8:11], v1, s[28:31], s48 offen offset:0
    s_add_u32 s48, s47, 24576
    buffer_load_dwordx4 v[8:11], v1, s[28:31], s48 offen offset:1024
    s_add_u32 s48, s47, 24576
    buffer_load_dwordx4 v[8:11], v1, s[28:31], s48 offen offset:2048
    s_add_u32 s48, s47, 24576
    buffer_load_dwordx4 v[8:11], v1, s[28:31], s48 offen offset:3072
    s_endpgm
K2_R_K2a0:
    s_nop 7
    s_nop 7
    v_mov_b32 v4, v6
    v_mov_b32 v5, v4
    s_nop 1
    v_permlane32_swap_b32 v4, v5
    v_max_f32 v4, v4, v5
    v_max_f32 v4, 0, v4
    v_sub_f32 v5, 0, v4
    v_exp_f32 v5, v5
    s_nop 0
    v_mul_f32 v72, v5, v72
    v_mul_f32 v73, v5, v73
    v_mul_f32 v74, v5, v74
    v_mul_f32 v75, v5, v75
    v_mul_f32 v76, v5, v76
    v_mul_f32 v77, v5, v77
    v_mul_f32 v78, v5, v78
    v_mul_f32 v79, v5, v79
    v_mul_f32 v80, v5, v80
    v_mul_f32 v81, v5, v81
    v_mul_f32 v82, v5, v82
    v_mul_f32 v83, v5, v83
    v_mul_f32 v84, v5, v84
    v_mul_f32 v85, v5, v85
    v_mul_f32 v86, v5, v86
    v_mul_f32 v87, v5, v87
    v_sub_f32 v56, v56, v4
    v_sub_f32 v57, v57, v4
    v_sub_f32 v58, v58, v4
    v_sub_f32 v59, v59, v4
    v_sub_f32 v60, v60, v4
    v_sub_f32 v61, v61, v4
    v_sub_f32 v62, v62, v4
    v_sub_f32 v63, v63, v4
    v_sub_f32 v64, v64, v4
    v_sub_f32 v65, v65, v4
    v_sub_f32 v66, v66, v4
    v_sub_f32 v67, v67, v4
    v_sub_f32 v68, v68, v4
    v_sub_f32 v69, v69, v4
    v_sub_f32 v70, v70, v4
    v_sub_f32 v71, v71, v4
    v_sub_f32 v24, v24, v4
    v_sub_f32 v25, v25, v4
    v_sub_f32 v26, v26, v4
    v_sub_f32 v27, v27, v4
    v_sub_f32 v28, v28, v4
    v_sub_f32 v29, v29, v4
    v_sub_f32 v30, v30, v4
    v_sub_f32 v31, v31, v4
    v_sub_f32 v32, v32, v4
    v_sub_f32 v33, v33, v4
    v_sub_f32 v34, v34, v4
    v_sub_f32 v35, v35, v4
    v_sub_f32 v36, v36, v4
    v_sub_f32 v37, v37, v4
    v_sub_f32 v38, v38, v4
    v_sub_f32 v39, v39, v4
    s_branch K2_B_K2a0
K2_R_K2a1:
    s_nop 7
    s_nop 7
    v_mov_b32 v4, v6
    v_mov_b32 v5, v4
    s_nop 1
    v_permlane32_swap_b32 v4, v5
    v_max_f32 v4, v4, v5
    v_max_f32 v4, 0, v4
    v_sub_f32 v5, 0, v4
    v_exp_f32 v5, v5
    s_nop 0
    v_mul_f32 v72, v5, v72
    v_mul_f32 v73, v5, v73
    v_mul_f32 v74, v5, v74
    v_mul_f32 v75, v5, v75
    v_mul_f32 v76, v5, v76
    v_mul_f32 v77, v5, v77
    v_mul_f32 v78, v5, v78
    v_mul_f32 v79, v5, v79
    v_mul_f32 v80, v5, v80
    v_mul_f32 v81, v5, v81
    v_mul_f32 v82, v5, v82
    v_mul_f32 v83, v5, v83
    v_mul_f32 v84, v5, v84
    v_mul_f32 v85, v5, v85
    v_mul_f32 v86, v5, v86
    v_mul_f32 v87, v5, v87
    v_sub_f32 v40, v40, v4
    v_sub_f32 v41, v41, v4
    v_sub_f32 v42, v42, v4
    v_sub_f32 v43, v43, v4
    v_sub_f32 v44, v44, v4
    v_sub_f32 v45, v45, v4
    v_sub_f32 v46, v46, v4
    v_sub_f32 v47, v47, v4
    v_sub_f32 v48, v48, v4
    v_sub_f32 v49, v49, v4
    v_sub_f32 v50, v50, v4
    v_sub_f32 v51, v51, v4
    v_sub_f32 v52, v52, v4
    v_sub_f32 v53, v53, v4
    v_sub_f32 v54, v54, v4
    v_sub_f32 v55, v55, v4
    v_sub_f32 v24, v24, v4
    v_sub_f32 v25, v25, v4
    v_sub_f32 v26, v26, v4
    v_sub_f32 v27, v27, v4
    v_sub_f32 v28, v28, v4
    v_sub_f32 v29, v29, v4
    v_sub_f32 v30, v30, v4
    v_sub_f32 v31, v31, v4
    v_sub_f32 v32, v32, v4
    v_sub_f32 v33, v33, v4
    v_sub_f32 v34, v34, v4
    v_sub_f32 v35, v35, v4
    v_sub_f32 v36, v36, v4
    v_sub_f32 v37, v37, v4
    v_sub_f32 v38, v38, v4
    v_sub_f32 v39, v39, v4
    s_branch K2_B_K2a1
K2_R_K2a2:
    s_nop 7
    s_nop 7
    v_mov_b32 v4, v6
    v_mov_b32 v5, v4
    s_nop 1
    v_permlane32_swap_b32 v4, v5
    v_max_f32 v4, v4, v5
    v_max_f32 v4, 0, v4
    v_sub_f32 v5, 0, v4
    v_exp_f32 v5, v5
    s_nop 0
    v_mul_f32 v72, v5, v72
    v_mul_f32 v73, v5, v73
    v_mul_f32 v74, v5, v74
    v_mul_f32 v75, v5, v75
    v_mul_f32 v76, v5, v76
    v_mul_f32 v77, v5, v77
    v_mul_f32 v78, v5, v78
    v_mul_f32 v79, v5, v79
    v_mul_f32 v80, v5, v80
    v_mul_f32 v81, v5, v81
    v_mul_f32 v82, v5, v82
    v_mul_f32 v83, v5, v83
    v_mul_f32 v84, v5, v84
    v_mul_f32 v85, v5, v85
    v_mul_f32 v86, v5, v86
    v_mul_f32 v87, v5, v87
    v_sub_f32 v56, v56, v4
    v_sub_f32 v57, v57, v4
    v_sub_f32 v58, v58, v4
    v_sub_f32 v59, v59, v4
    v_sub_f32 v60, v60, v4
    v_sub_f32 v61, v61, v4
    v_sub_f32 v62, v62, v4
    v_sub_f32 v63, v63, v4
    v_sub_f32 v64, v64, v4
    v_sub_f32 v65, v65, v4
    v_sub_f32 v66, v66, v4
    v_sub_f32 v67, v67, v4
    v_sub_f32 v68, v68, v4
    v_sub_f32 v69, v69, v4
    v_sub_f32 v70, v70, v4
    v_sub_f32 v71, v71, v4
    v_sub_f32 v24, v24, v4
    v_sub_f32 v25, v25, v4
    v_sub_f32 v26, v26, v4
    v_sub_f32 v27, v27, v4
    v_sub_f32 v28, v28, v4
    v_sub_f32 v29, v29, v4
    v_sub_f32 v30, v30, v4
    v_sub_f32 v31, v31, v4
    v_sub_f32 v32, v32, v4
    v_sub_f32 v33, v33, v4
    v_sub_f32 v34, v34, v4
    v_sub_f32 v35, v35, v4
    v_sub_f32 v36, v36, v4
    v_sub_f32 v37, v37, v4
    v_sub_f32 v38, v38, v4
    v_sub_f32 v39, v39, v4
    s_branch K2_B_K2a2
K2_R_K2a3:
    s_nop 7
    s_nop 7
    v_mov_b32 v4, v6
    v_mov_b32 v5, v4
    s_nop 1
    v_permlane32_swap_b32 v4, v5
    v_max_f32 v4, v4, v5
    v_max_f32 v4, 0, v4
    v_sub_f32 v5, 0, v4
    v_exp_f32 v5, v5
    s_nop 0
    v_mul_f32 v72, v5, v72
    v_mul_f32 v73, v5, v73
    v_mul_f32 v74, v5, v74
    v_mul_f32 v75, v5, v75
    v_mul_f32 v76, v5, v76
    v_mul_f32 v77, v5, v77
    v_mul_f32 v78, v5, v78
    v_mul_f32 v79, v5, v79
    v_mul_f32 v80, v5, v80
    v_mul_f32 v81, v5, v81
    v_mul_f32 v82, v5, v82
    v_mul_f32 v83, v5, v83
    v_mul_f32 v84, v5, v84
    v_mul_f32 v85, v5, v85
    v_mul_f32 v86, v5, v86
    v_mul_f32 v87, v5, v87
    v_sub_f32 v40, v40, v4
    v_sub_f32 v41, v41, v4
    v_sub_f32 v42, v42, v4
    v_sub_f32 v43, v43, v4
    v_sub_f32 v44, v44, v4
    v_sub_f32 v45, v45, v4
    v_sub_f32 v46, v46, v4
    v_sub_f32 v47, v47, v4
    v_sub_f32 v48, v48, v4
    v_sub_f32 v49, v49, v4
    v_sub_f32 v50, v50, v4
    v_sub_f32 v51, v51, v4
    v_sub_f32 v52, v52, v4
    v_sub_f32 v53, v53, v4
    v_sub_f32 v54, v54, v4
    v_sub_f32 v55, v55, v4
    v_sub_f32 v24, v24, v4
    v_sub_f32 v25, v25, v4
    v_sub_f32 v26, v26, v4
    v_sub_f32 v27, v27, v4
    v_sub_f32 v28, v28, v4
    v_sub_f32 v29, v29, v4
    v_sub_f32 v30, v30, v4
    v_sub_f32 v31, v31, v4
    v_sub_f32 v32, v32, v4
    v_sub_f32 v33, v33, v4
    v_sub_f32 v34, v34, v4
    v_sub_f32 v35, v35, v4
    v_sub_f32 v36, v36, v4
    v_sub_f32 v37, v37, v4
    v_sub_f32 v38, v38, v4
    v_sub_f32 v39, v39, v4
    s_branch K2_B_K2a3
K2_R_K2a4:
    s_nop 7
    s_nop 7
    v_mov_b32 v4, v6
    v_mov_b32 v5, v4
    s_nop 1
    v_permlane32_swap_b32 v4, v5
    v_max_f32 v4, v4, v5
    v_max_f32 v4, 0, v4
    v_sub_f32 v5, 0, v4
    v_exp_f32 v5, v5
    s_nop 0
    v_mul_f32 v72, v5, v72
    v_mul_f32 v73, v5, v73
    v_mul_f32 v74, v5, v74
    v_mul_f32 v75, v5, v75
    v_mul_f32 v76, v5, v76
    v_mul_f32 v77, v5, v77
    v_mul_f32 v78, v5, v78
    v_mul_f32 v79, v5, v79
    v_mul_f32 v80, v5, v80
    v_mul_f32 v81, v5, v81
    v_mul_f32 v82, v5, v82
    v_mul_f32 v83, v5, v83
    v_mul_f32 v84, v5, v84
    v_mul_f32 v85, v5, v85
    v_mul_f32 v86, v5, v86
    v_mul_f32 v87, v5, v87
    v_sub_f32 v56, v56, v4
    v_sub_f32 v57, v57, v4
    v_sub_f32 v58, v58, v4
    v_sub_f32 v59, v59, v4
    v_sub_f32 v60, v60, v4
    v_sub_f32 v61, v61, v4
    v_sub_f32 v62, v62, v4
    v_sub_f32 v63, v63, v4
    v_sub_f32 v64, v64, v4
    v_sub_f32 v65, v65, v4
    v_sub_f32 v66, v66, v4
    v_sub_f32 v67, v67, v4
    v_sub_f32 v68, v68, v4
    v_sub_f32 v69, v69, v4
    v_sub_f32 v70, v70, v4
    v_sub_f32 v71, v71, v4
    v_sub_f32 v24, v24, v4
    v_sub_f32 v25, v25, v4
    v_sub_f32 v26, v26, v4
    v_sub_f32 v27, v27, v4
    v_sub_f32 v28, v28, v4
    v_sub_f32 v29, v29, v4
    v_sub_f32 v30, v30, v4
    v_sub_f32 v31, v31, v4
    v_sub_f32 v32, v32, v4
    v_sub_f32 v33, v33, v4
    v_sub_f32 v34, v34, v4
    v_sub_f32 v35, v35, v4
    v_sub_f32 v36, v36, v4
    v_sub_f32 v37, v37, v4
    v_sub_f32 v38, v38, v4
    v_sub_f32 v39, v39, v4
    s_branch K2_B_K2a4
K2_R_K2a5:
    s_nop 7
    s_nop 7
    v_mov_b32 v4, v6
    v_mov_b32 v5, v4
    s_nop 1
    v_permlane32_swap_b32 v4, v5
    v_max_f32 v4, v4, v5
    v_max_f32 v4, 0, v4
    v_sub_f32 v5, 0, v4
    v_exp_f32 v5, v5
    s_nop 0
    v_mul_f32 v72, v5, v72
    v_mul_f32 v73, v5, v73
    v_mul_f32 v74, v5, v74
    v_mul_f32 v75, v5, v75
    v_mul_f32 v76, v5, v76
    v_mul_f32 v77, v5, v77
    v_mul_f32 v78, v5, v78
    v_mul_f32 v79, v5, v79
    v_mul_f32 v80, v5, v80
    v_mul_f32 v81, v5, v81
    v_mul_f32 v82, v5, v82
    v_mul_f32 v83, v5, v83
    v_mul_f32 v84, v5, v84
    v_mul_f32 v85, v5, v85
    v_mul_f32 v86, v5, v86
    v_mul_f32 v87, v5, v87
    v_sub_f32 v40, v40, v4
    v_sub_f32 v41, v41, v4
    v_sub_f32 v42, v42, v4
    v_sub_f32 v43, v43, v4
    v_sub_f32 v44, v44, v4
    v_sub_f32 v45, v45, v4
    v_sub_f32 v46, v46, v4
    v_sub_f32 v47, v47, v4
    v_sub_f32 v48, v48, v4
    v_sub_f32 v49, v49, v4
    v_sub_f32 v50, v50, v4
    v_sub_f32 v51, v51, v4
    v_sub_f32 v52, v52, v4
    v_sub_f32 v53, v53, v4
    v_sub_f32 v54, v54, v4
    v_sub_f32 v55, v55, v4
    v_sub_f32 v24, v24, v4
    v_sub_f32 v25, v25, v4
    v_sub_f32 v26, v26, v4
    v_sub_f32 v27, v27, v4
    v_sub_f32 v28, v28, v4
    v_sub_f32 v29, v29, v4
    v_sub_f32 v30, v30, v4
    v_sub_f32 v31, v31, v4
    v_sub_f32 v32, v32, v4
    v_sub_f32 v33, v33, v4
    v_sub_f32 v34, v34, v4
    v_sub_f32 v35, v35, v4
    v_sub_f32 v36, v36, v4
    v_sub_f32 v37, v37, v4
    v_sub_f32 v38, v38, v4
    v_sub_f32 v39, v39, v4
    s_branch K2_B_K2a5
K2_R_K2a6:
    s_nop 7
    s_nop 7
    v_mov_b32 v4, v6
    v_mov_b32 v5, v4
    s_nop 1
    v_permlane32_swap_b32 v4, v5
    v_max_f32 v4, v4, v5
    v_max_f32 v4, 0, v4
    v_sub_f32 v5, 0, v4
    v_exp_f32 v5, v5
    s_nop 0
    v_mul_f32 v72, v5, v72
    v_mul_f32 v73, v5, v73
    v_mul_f32 v74, v5, v74
    v_mul_f32 v75, v5, v75
    v_mul_f32 v76, v5, v76
    v_mul_f32 v77, v5, v77
    v_mul_f32 v78, v5, v78
    v_mul_f32 v79, v5, v79
    v_mul_f32 v80, v5, v80
    v_mul_f32 v81, v5, v81
    v_mul_f32 v82, v5, v82
    v_mul_f32 v83, v5, v83
    v_mul_f32 v84, v5, v84
    v_mul_f32 v85, v5, v85
    v_mul_f32 v86, v5, v86
    v_mul_f32 v87, v5, v87
    v_sub_f32 v56, v56, v4
    v_sub_f32 v57, v57, v4
    v_sub_f32 v58, v58, v4
    v_sub_f32 v59, v59, v4
    v_sub_f32 v60, v60, v4
    v_sub_f32 v61, v61, v4
    v_sub_f32 v62, v62, v4
    v_sub_f32 v63, v63, v4
    v_sub_f32 v64, v64, v4
    v_sub_f32 v65, v65, v4
    v_sub_f32 v66, v66, v4
    v_sub_f32 v67, v67, v4
    v_sub_f32 v68, v68, v4
    v_sub_f32 v69, v69, v4
    v_sub_f32 v70, v70, v4
    v_sub_f32 v71, v71, v4
    v_sub_f32 v24, v24, v4
    v_sub_f32 v25, v25, v4
    v_sub_f32 v26, v26, v4
    v_sub_f32 v27, v27, v4
    v_sub_f32 v28, v28, v4
    v_sub_f32 v29, v29, v4
    v_sub_f32 v30, v30, v4
    v_sub_f32 v31, v31, v4
    v_sub_f32 v32, v32, v4
    v_sub_f32 v33, v33, v4
    v_sub_f32 v34, v34, v4
    v_sub_f32 v35, v35, v4
    v_sub_f32 v36, v36, v4
    v_sub_f32 v37, v37, v4
    v_sub_f32 v38, v38, v4
    v_sub_f32 v39, v39, v4
    s_branch K2_B_K2a6
K2_R_K2a7:
    s_nop 7
    s_nop 7
    v_mov_b32 v4, v6
    v_mov_b32 v5, v4
    s_nop 1
    v_permlane32_swap_b32 v4, v5
    v_max_f32 v4, v4, v5
    v_max_f32 v4, 0, v4
    v_sub_f32 v5, 0, v4
    v_exp_f32 v5, v5
    s_nop 0
    v_mul_f32 v72, v5, v72
    v_mul_f32 v73, v5, v73
    v_mul_f32 v74, v5, v74
    v_mul_f32 v75, v5, v75
    v_mul_f32 v76, v5, v76
    v_mul_f32 v77, v5, v77
    v_mul_f32 v78, v5, v78
    v_mul_f32 v79, v5, v79
    v_mul_f32 v80, v5, v80
    v_mul_f32 v81, v5, v81
    v_mul_f32 v82, v5, v82
    v_mul_f32 v83, v5, v83
    v_mul_f32 v84, v5, v84
    v_mul_f32 v85, v5, v85
    v_mul_f32 v86, v5, v86
    v_mul_f32 v87, v5, v87
    v_sub_f32 v40, v40, v4
    v_sub_f32 v41, v41, v4
    v_sub_f32 v42, v42, v4
    v_sub_f32 v43, v43, v4
    v_sub_f32 v44, v44, v4
    v_sub_f32 v45, v45, v4
    v_sub_f32 v46, v46, v4
    v_sub_f32 v47, v47, v4
    v_sub_f32 v48, v48, v4
    v_sub_f32 v49, v49, v4
    v_sub_f32 v50, v50, v4
    v_sub_f32 v51, v51, v4
    v_sub_f32 v52, v52, v4
    v_sub_f32 v53, v53, v4
    v_sub_f32 v54, v54, v4
    v_sub_f32 v55, v55, v4
    v_sub_f32 v24, v24, v4
    v_sub_f32 v25, v25, v4
    v_sub_f32 v26, v26, v4
    v_sub_f32 v27, v27, v4
    v_sub_f32 v28, v28, v4
    v_sub_f32 v29, v29, v4
    v_sub_f32 v30, v30, v4
    v_sub_f32 v31, v31, v4
    v_sub_f32 v32, v32, v4
    v_sub_f32 v33, v33, v4
    v_sub_f32 v34, v34, v4
    v_sub_f32 v35, v35, v4
    v_sub_f32 v36, v36, v4
    v_sub_f32 v37, v37, v4
    v_sub_f32 v38, v38, v4
    v_sub_f32 v39, v39, v4
    s_branch K2_B_K2a7
K2_R_K2b0:
    s_nop 7
    s_nop 7
    v_mov_b32 v4, v6
    v_mov_b32 v5, v4
    s_nop 1
    v_permlane32_swap_b32 v4, v5
    v_max_f32 v4, v4, v5
    v_max_f32 v4, 0, v4
    v_sub_f32 v5, 0, v4
    v_exp_f32 v5, v5
    s_nop 0
    v_mul_f32 v72, v5, v72
    v_mul_f32 v73, v5, v73
    v_mul_f32 v74, v5, v74
    v_mul_f32 v75, v5, v75
    v_mul_f32 v76, v5, v76
    v_mul_f32 v77, v5, v77
    v_mul_f32 v78, v5, v78
    v_mul_f32 v79, v5, v79
    v_mul_f32 v80, v5, v80
    v_mul_f32 v81, v5, v81
    v_mul_f32 v82, v5, v82
    v_mul_f32 v83, v5, v83
    v_mul_f32 v84, v5, v84
    v_mul_f32 v85, v5, v85
    v_mul_f32 v86, v5, v86
    v_mul_f32 v87, v5, v87
    v_sub_f32 v56, v56, v4
    v_sub_f32 v57, v57, v4
    v_sub_f32 v58, v58, v4
    v_sub_f32 v59, v59, v4
    v_sub_f32 v60, v60, v4
    v_sub_f32 v61, v61, v4
    v_sub_f32 v62, v62, v4
    v_sub_f32 v63, v63, v4
    v_sub_f32 v64, v64, v4
    v_sub_f32 v65, v65, v4
    v_sub_f32 v66, v66, v4
    v_sub_f32 v67, v67, v4
    v_sub_f32 v68, v68, v4
    v_sub_f32 v69, v69, v4
    v_sub_f32 v70, v70, v4
    v_sub_f32 v71, v71, v4
    v_sub_f32 v24, v24, v4
    v_sub_f32 v25, v25, v4
    v_sub_f32 v26, v26, v4
    v_sub_f32 v27, v27, v4
    v_sub_f32 v28, v28, v4
    v_sub_f32 v29, v29, v4
    v_sub_f32 v30, v30, v4
    v_sub_f32 v31, v31, v4
    v_sub_f32 v32, v32, v4
    v_sub_f32 v33, v33, v4
    v_sub_f32 v34, v34, v4
    v_sub_f32 v35, v35, v4
    v_sub_f32 v36, v36, v4
    v_sub_f32 v37, v37, v4
    v_sub_f32 v38, v38, v4
    v_sub_f32 v39, v39, v4
    s_branch K2_B_K2b0
K2_R_K2b1:
    s_nop 7
    s_nop 7
    v_mov_b32 v4, v6
    v_mov_b32 v5, v4
    s_nop 1
    v_permlane32_swap_b32 v4, v5
    v_max_f32 v4, v4, v5
    v_max_f32 v4, 0, v4
    v_sub_f32 v5, 0, v4
    v_exp_f32 v5, v5
    s_nop 0
    v_mul_f32 v72, v5, v72
    v_mul_f32 v73, v5, v73
    v_mul_f32 v74, v5, v74
    v_mul_f32 v75, v5, v75
    v_mul_f32 v76, v5, v76
    v_mul_f32 v77, v5, v77
    v_mul_f32 v78, v5, v78
    v_mul_f32 v79, v5, v79
    v_mul_f32 v80, v5, v80
    v_mul_f32 v81, v5, v81
    v_mul_f32 v82, v5, v82
    v_mul_f32 v83, v5, v83
    v_mul_f32 v84, v5, v84
    v_mul_f32 v85, v5, v85
    v_mul_f32 v86, v5, v86
    v_mul_f32 v87, v5, v87
    v_sub_f32 v40, v40, v4
    v_sub_f32 v41, v41, v4
    v_sub_f32 v42, v42, v4
    v_sub_f32 v43, v43, v4
    v_sub_f32 v44, v44, v4
    v_sub_f32 v45, v45, v4
    v_sub_f32 v46, v46, v4
    v_sub_f32 v47, v47, v4
    v_sub_f32 v48, v48, v4
    v_sub_f32 v49, v49, v4
    v_sub_f32 v50, v50, v4
    v_sub_f32 v51, v51, v4
    v_sub_f32 v52, v52, v4
    v_sub_f32 v53, v53, v4
    v_sub_f32 v54, v54, v4
    v_sub_f32 v55, v55, v4
    v_sub_f32 v24, v24, v4
    v_sub_f32 v25, v25, v4
    v_sub_f32 v26, v26, v4
    v_sub_f32 v27, v27, v4
    v_sub_f32 v28, v28, v4
    v_sub_f32 v29, v29, v4
    v_sub_f32 v30, v30, v4
    v_sub_f32 v31, v31, v4
    v_sub_f32 v32, v32, v4
    v_sub_f32 v33, v33, v4
    v_sub_f32 v34, v34, v4
    v_sub_f32 v35, v35, v4
    v_sub_f32 v36, v36, v4
    v_sub_f32 v37, v37, v4
    v_sub_f32 v38, v38, v4
    v_sub_f32 v39, v39, v4
    s_branch K2_B_K2b1
K2_R_K2b2:
    s_nop 7
    s_nop 7
    v_mov_b32 v4, v6
    v_mov_b32 v5, v4
    s_nop 1
    v_permlane32_swap_b32 v4, v5
    v_max_f32 v4, v4, v5
    v_max_f32 v4, 0, v4
    v_sub_f32 v5, 0, v4
    v_exp_f32 v5, v5
    s_nop 0
    v_mul_f32 v72, v5, v72
    v_mul_f32 v73, v5, v73
    v_mul_f32 v74, v5, v74
    v_mul_f32 v75, v5, v75
    v_mul_f32 v76, v5, v76
    v_mul_f32 v77, v5, v77
    v_mul_f32 v78, v5, v78
    v_mul_f32 v79, v5, v79
    v_mul_f32 v80, v5, v80
    v_mul_f32 v81, v5, v81
    v_mul_f32 v82, v5, v82
    v_mul_f32 v83, v5, v83
    v_mul_f32 v84, v5, v84
    v_mul_f32 v85, v5, v85
    v_mul_f32 v86, v5, v86
    v_mul_f32 v87, v5, v87
    v_sub_f32 v56, v56, v4
    v_sub_f32 v57, v57, v4
    v_sub_f32 v58, v58, v4
    v_sub_f32 v59, v59, v4
    v_sub_f32 v60, v60, v4
    v_sub_f32 v61, v61, v4
    v_sub_f32 v62, v62, v4
    v_sub_f32 v63, v63, v4
    v_sub_f32 v64, v64, v4
    v_sub_f32 v65, v65, v4
    v_sub_f32 v66, v66, v4
    v_sub_f32 v67, v67, v4
    v_sub_f32 v68, v68, v4
    v_sub_f32 v69, v69, v4
    v_sub_f32 v70, v70, v4
    v_sub_f32 v71, v71, v4
    v_sub_f32 v24, v24, v4
    v_sub_f32 v25, v25, v4
    v_sub_f32 v26, v26, v4
    v_sub_f32 v27, v27, v4
    v_sub_f32 v28, v28, v4
    v_sub_f32 v29, v29, v4
    v_sub_f32 v30, v30, v4
    v_sub_f32 v31, v31, v4
    v_sub_f32 v32, v32, v4
    v_sub_f32 v33, v33, v4
    v_sub_f32 v34, v34, v4
    v_sub_f32 v35, v35, v4
    v_sub_f32 v36, v36, v4
    v_sub_f32 v37, v37, v4
    v_sub_f32 v38, v38, v4
    v_sub_f32 v39, v39, v4
    s_branch K2_B_K2b2
K2_R_K2b3:
    s_nop 7
    s_nop 7
    v_mov_b32 v4, v6
    v_mov_b32 v5, v4
    s_nop 1
    v_permlane32_swap_b32 v4, v5
    v_max_f32 v4, v4, v5
    v_max_f32 v4, 0, v4
    v_sub_f32 v5, 0, v4
    v_exp_f32 v5, v5
    s_nop 0
    v_mul_f32 v72, v5, v72
    v_mul_f32 v73, v5, v73
    v_mul_f32 v74, v5, v74
    v_mul_f32 v75, v5, v75
    v_mul_f32 v76, v5, v76
    v_mul_f32 v77, v5, v77
    v_mul_f32 v78, v5, v78
    v_mul_f32 v79, v5, v79
    v_mul_f32 v80, v5, v80
    v_mul_f32 v81, v5, v81
    v_mul_f32 v82, v5, v82
    v_mul_f32 v83, v5, v83
    v_mul_f32 v84, v5, v84
    v_mul_f32 v85, v5, v85
    v_mul_f32 v86, v5, v86
    v_mul_f32 v87, v5, v87
    v_sub_f32 v40, v40, v4
    v_sub_f32 v41, v41, v4
    v_sub_f32 v42, v42, v4
    v_sub_f32 v43, v43, v4
    v_sub_f32 v44, v44, v4
    v_sub_f32 v45, v45, v4
    v_sub_f32 v46, v46, v4
    v_sub_f32 v47, v47, v4
    v_sub_f32 v48, v48, v4
    v_sub_f32 v49, v49, v4
    v_sub_f32 v50, v50, v4
    v_sub_f32 v51, v51, v4
    v_sub_f32 v52, v52, v4
    v_sub_f32 v53, v53, v4
    v_sub_f32 v54, v54, v4
    v_sub_f32 v55, v55, v4
    v_sub_f32 v24, v24, v4
    v_sub_f32 v25, v25, v4
    v_sub_f32 v26, v26, v4
    v_sub_f32 v27, v27, v4
    v_sub_f32 v28, v28, v4
    v_sub_f32 v29, v29, v4
    v_sub_f32 v30, v30, v4
    v_sub_f32 v31, v31, v4
    v_sub_f32 v32, v32, v4
    v_sub_f32 v33, v33, v4
    v_sub_f32 v34, v34, v4
    v_sub_f32 v35, v35, v4
    v_sub_f32 v36, v36, v4
    v_sub_f32 v37, v37, v4
    v_sub_f32 v38, v38, v4
    v_sub_f32 v39, v39, v4
    s_branch K2_B_K2b3
K2_R_K2b4:
    s_nop 7
    s_nop 7
    v_mov_b32 v4, v6
    v_mov_b32 v5, v4
    s_nop 1
    v_permlane32_swap_b32 v4, v5
    v_max_f32 v4, v4, v5
    v_max_f32 v4, 0, v4
    v_sub_f32 v5, 0, v4
    v_exp_f32 v5, v5
    s_nop 0
    v_mul_f32 v72, v5, v72
    v_mul_f32 v73, v5, v73
    v_mul_f32 v74, v5, v74
    v_mul_f32 v75, v5, v75
    v_mul_f32 v76, v5, v76
    v_mul_f32 v77, v5, v77
    v_mul_f32 v78, v5, v78
    v_mul_f32 v79, v5, v79
    v_mul_f32 v80, v5, v80
    v_mul_f32 v81, v5, v81
    v_mul_f32 v82, v5, v82
    v_mul_f32 v83, v5, v83
    v_mul_f32 v84, v5, v84
    v_mul_f32 v85, v5, v85
    v_mul_f32 v86, v5, v86
    v_mul_f32 v87, v5, v87
    v_sub_f32 v56, v56, v4
    v_sub_f32 v57, v57, v4
    v_sub_f32 v58, v58, v4
    v_sub_f32 v59, v59, v4
    v_sub_f32 v60, v60, v4
    v_sub_f32 v61, v61, v4
    v_sub_f32 v62, v62, v4
    v_sub_f32 v63, v63, v4
    v_sub_f32 v64, v64, v4
    v_sub_f32 v65, v65, v4
    v_sub_f32 v66, v66, v4
    v_sub_f32 v67, v67, v4
    v_sub_f32 v68, v68, v4
    v_sub_f32 v69, v69, v4
    v_sub_f32 v70, v70, v4
    v_sub_f32 v71, v71, v4
    v_sub_f32 v24, v24, v4
    v_sub_f32 v25, v25, v4
    v_sub_f32 v26, v26, v4
    v_sub_f32 v27, v27, v4
    v_sub_f32 v28, v28, v4
    v_sub_f32 v29, v29, v4
    v_sub_f32 v30, v30, v4
    v_sub_f32 v31, v31, v4
    v_sub_f32 v32, v32, v4
    v_sub_f32 v33, v33, v4
    v_sub_f32 v34, v34, v4
    v_sub_f32 v35, v35, v4
    v_sub_f32 v36, v36, v4
    v_sub_f32 v37, v37, v4
    v_sub_f32 v38, v38, v4
    v_sub_f32 v39, v39, v4
    s_branch K2_B_K2b4
K2_R_K2b5:
    s_nop 7
    s_nop 7
    v_mov_b32 v4, v6
    v_mov_b32 v5, v4
    s_nop 1
    v_permlane32_swap_b32 v4, v5
    v_max_f32 v4, v4, v5
    v_max_f32 v4, 0, v4
    v_sub_f32 v5, 0, v4
    v_exp_f32 v5, v5
    s_nop 0
    v_mul_f32 v72, v5, v72
    v_mul_f32 v73, v5, v73
    v_mul_f32 v74, v5, v74
    v_mul_f32 v75, v5, v75
    v_mul_f32 v76, v5, v76
    v_mul_f32 v77, v5, v77
    v_mul_f32 v78, v5, v78
    v_mul_f32 v79, v5, v79
    v_mul_f32 v80, v5, v80
    v_mul_f32 v81, v5, v81
    v_mul_f32 v82, v5, v82
    v_mul_f32 v83, v5, v83
    v_mul_f32 v84, v5, v84
    v_mul_f32 v85, v5, v85
    v_mul_f32 v86, v5, v86
    v_mul_f32 v87, v5, v87
    v_sub_f32 v40, v40, v4
    v_sub_f32 v41, v41, v4
    v_sub_f32 v42, v42, v4
    v_sub_f32 v43, v43, v4
    v_sub_f32 v44, v44, v4
    v_sub_f32 v45, v45, v4
    v_sub_f32 v46, v46, v4
    v_sub_f32 v47, v47, v4
    v_sub_f32 v48, v48, v4
    v_sub_f32 v49, v49, v4
    v_sub_f32 v50, v50, v4
    v_sub_f32 v51, v51, v4
    v_sub_f32 v52, v52, v4
    v_sub_f32 v53, v53, v4
    v_sub_f32 v54, v54, v4
    v_sub_f32 v55, v55, v4
    v_sub_f32 v24, v24, v4
    v_sub_f32 v25, v25, v4
    v_sub_f32 v26, v26, v4
    v_sub_f32 v27, v27, v4
    v_sub_f32 v28, v28, v4
    v_sub_f32 v29, v29, v4
    v_sub_f32 v30, v30, v4
    v_sub_f32 v31, v31, v4
    v_sub_f32 v32, v32, v4
    v_sub_f32 v33, v33, v4
    v_sub_f32 v34, v34, v4
    v_sub_f32 v35, v35, v4
    v_sub_f32 v36, v36, v4
    v_sub_f32 v37, v37, v4
    v_sub_f32 v38, v38, v4
    v_sub_f32 v39, v39, v4
    s_branch K2_B_K2b5
K2_R_K2b6:
    s_nop 7
    s_nop 7
    v_mov_b32 v4, v6
    v_mov_b32 v5, v4
    s_nop 1
    v_permlane32_swap_b32 v4, v5
    v_max_f32 v4, v4, v5
    v_max_f32 v4, 0, v4
    v_sub_f32 v5, 0, v4
    v_exp_f32 v5, v5
    s_nop 0
    v_mul_f32 v72, v5, v72
    v_mul_f32 v73, v5, v73
    v_mul_f32 v74, v5, v74
    v_mul_f32 v75, v5, v75
    v_mul_f32 v76, v5, v76
    v_mul_f32 v77, v5, v77
    v_mul_f32 v78, v5, v78
    v_mul_f32 v79, v5, v79
    v_mul_f32 v80, v5, v80
    v_mul_f32 v81, v5, v81
    v_mul_f32 v82, v5, v82
    v_mul_f32 v83, v5, v83
    v_mul_f32 v84, v5, v84
    v_mul_f32 v85, v5, v85
    v_mul_f32 v86, v5, v86
    v_mul_f32 v87, v5, v87
    v_sub_f32 v56, v56, v4
    v_sub_f32 v57, v57, v4
    v_sub_f32 v58, v58, v4
    v_sub_f32 v59, v59, v4
    v_sub_f32 v60, v60, v4
    v_sub_f32 v61, v61, v4
    v_sub_f32 v62, v62, v4
    v_sub_f32 v63, v63, v4
    v_sub_f32 v64, v64, v4
    v_sub_f32 v65, v65, v4
    v_sub_f32 v66, v66, v4
    v_sub_f32 v67, v67, v4
    v_sub_f32 v68, v68, v4
    v_sub_f32 v69, v69, v4
    v_sub_f32 v70, v70, v4
    v_sub_f32 v71, v71, v4
    v_sub_f32 v24, v24, v4
    v_sub_f32 v25, v25, v4
    v_sub_f32 v26, v26, v4
    v_sub_f32 v27, v27, v4
    v_sub_f32 v28, v28, v4
    v_sub_f32 v29, v29, v4
    v_sub_f32 v30, v30, v4
    v_sub_f32 v31, v31, v4
    v_sub_f32 v32, v32, v4
    v_sub_f32 v33, v33, v4
    v_sub_f32 v34, v34, v4
    v_sub_f32 v35, v35, v4
    v_sub_f32 v36, v36, v4
    v_sub_f32 v37, v37, v4
    v_sub_f32 v38, v38, v4
    v_sub_f32 v39, v39, v4
    s_branch K2_B_K2b6
K2_END:
    s_endpgm
.section .rodata,"a"
.p2align 6
.amdhsa_kernel k2_kernel
  .amdhsa_next_free_vgpr 128
  .amdhsa_next_free_sgpr 102
  .amdhsa_accum_offset 128
  .amdhsa_group_segment_fixed_size 0
  .amdhsa_kernarg_size 104
  .amdhsa_user_sgpr_count 2
  .amdhsa_user_sgpr_kernarg_segment_ptr 1
  .amdhsa_system_sgpr_workgroup_id_x 1
.end_amdhsa_kernel
.text
.globl k3_kernel
.p2align 8
.type k3_kernel,@function
k3_kernel:
    s_cmp_ge_u32 s2, 64
    s_cbranch_scc1 K3_END
    s_load_dwordx2 s[4:5], s[0:1], 0
    s_load_dwordx2 s[6:7], s[0:1], 32
    s_load_dwordx2 s[12:13], s[0:1], 96
    v_lshrrev_b32 v1, 6, v0
    v_and_b32 v2, 63, v0
    v_readfirstlane_b32 s30, v1
    s_movk_i32 s31, 896
    v_lshlrev_b32 v1, 4, v2
    v_lshrrev_b32 v4, 3, v2
    v_mul_lo_u32 v3, v4, s31
    v_bfe_u32 v4, v2, 4, 1
    v_lshlrev_b32 v4, 2, v4
    v_xor_b32 v4, v4, v2
    v_and_b32 v4, 7, v4
    v_lshl_add_u32 v3, v4, 4, v3
    v_lshrrev_b32 v7, 5, v2
    v_lshlrev_b32 v7, 2, v7
    v_bfe_u32 v8, v2, 2, 2
    v_add_u32 v7, v7, v8
    v_lshlrev_b32 v5, 7, v7
    v_bfe_u32 v8, v2, 4, 1
    v_lshl_add_u32 v5, v8, 5, v5
    v_and_b32 v8, 3, v2
    v_lshl_add_u32 v5, v8, 3, v5
    v_bfe_u32 v8, v2, 3, 1
    v_lshlrev_b32 v8, 6, v8
    v_xor_b32 v5, v5, v8
    v_xor_b32 v6, 64, v5
    s_mul_i32 s32, s30, 12288
    s_add_u32 s32, s32, 32768
    v_add_u32 v5, s32, v5
    v_add_u32 v6, s32, v6
    s_lshl_b32 s33, s30, 7
    v_add_u32 v3, s33, v3
    s_waitcnt lgkmcnt(0)
    s_mov_b32 s16, s4
    s_and_b32 s17, s5, 0xffff
    s_mov_b32 s18, 1835008
    s_mov_b32 s19, 0x00020000
    s_mov_b32 s20, s6
    s_and_b32 s21, s7, 0xffff
    s_mov_b32 s22, 401408
    s_mov_b32 s23, 0x00020000
    s_mov_b32 s24, s12
    s_and_b32 s25, s13, 0xffff
    s_mov_b32 s26, 67108864
    s_mov_b32 s27, 0x00020000
    s_lshl_b32 s34, s2, 15
    s_add_u32 s34, s34, 2359296
    s_lshl_b32 s36, s30, 10
    s_add_u32 s37, s34, s36
    s_mov_b32 m0, s36
    s_nop 0
    buffer_load_dwordx4 v1, s[24:27], s37 offen lds
    s_add_u32 s36, s36, 7168
    s_add_u32 s37, s34, s36
    s_mov_b32 m0, s36
    s_nop 0
    buffer_load_dwordx4 v1, s[24:27], s37 offen lds
    s_add_u32 s36, s36, 7168
    s_add_u32 s37, s34, s36
    s_mov_b32 m0, s36
    s_nop 0
    buffer_load_dwordx4 v1, s[24:27], s37 offen lds
    s_add_u32 s36, s36, 7168
    s_add_u32 s37, s34, s36
    s_mov_b32 m0, s36
    s_nop 0
    buffer_load_dwordx4 v1, s[24:27], s37 offen lds
    s_add_u32 s36, s36, 7168
    s_min_u32 s36, s36, 31744
    s_add_u32 s37, s34, s36
    s_mov_b32 m0, s36
    s_nop 0
    buffer_load_dwordx4 v1, s[24:27], s37 offen lds
    s_add_u32 s36, s36, 7168
    s_add_u32 s40, s32, 0
    s_mov_b32 m0, s40
    s_mov_b32 s41, 0
    buffer_load_dwordx4 v3, s[20:23], s41 offen lds
    s_add_u32 s40, s32, 1024
    s_mov_b32 m0, s40
    s_mov_b32 s41, 7168
    buffer_load_dwordx4 v3, s[20:23], s41 offen lds
    s_add_u32 s40, s32, 2048
    s_mov_b32 m0, s40
    s_mov_b32 s41, 14336
    buffer_load_dwordx4 v3, s[20:23], s41 offen lds
    s_add_u32 s40, s32, 3072
    s_mov_b32 m0, s40
    s_mov_b32 s41, 21504
    buffer_load_dwordx4 v3, s[20:23], s41 offen lds
    s_add_u32 s40, s32, 4096
    s_mov_b32 m0, s40
    s_mov_b32 s41, 25088
    buffer_load_dwordx4 v3, s[20:23], s41 offen lds
    s_add_u32 s40, s32, 5120
    s_mov_b32 m0, s40
    s_mov_b32 s41, 32256
    buffer_load_dwordx4 v3, s[20:23], s41 offen lds
    s_add_u32 s40, s32, 6144
    s_mov_b32 m0, s40
    s_mov_b32 s41, 39424
    buffer_load_dwordx4 v3, s[20:23], s41 offen lds
    s_add_u32 s40, s32, 7168
    s_mov_b32 m0, s40
    s_mov_b32 s41, 46592
    buffer_load_dwordx4 v3, s[20:23], s41 offen lds
    s_add_u32 s40, s32, 8192
    s_mov_b32 m0, s40
    s_mov_b32 s41, 50176
    buffer_load_dwordx4 v3, s[20:23], s41 offen lds
    s_add_u32 s40, s32, 9216
    s_mov_b32 m0, s40
    s_mov_b32 s41, 57344
    buffer_load_dwordx4 v3, s[20:23], s41 offen lds
    s_lshl_b32 s38, s2, 5
    s_add_u32 s38, s38, s30
    s_mul_i32 s38, s38, 896
    s_mul_i32 s39, s30, 912
    s_add_u32 s39, s39, 118784
    s_mov_b64 s[50:51], exec
    s_mov_b32 exec_hi, 0x00ffffff
    s_mov_b32 m0, s39
    s_add_u32 s39, s39, 6384
    buffer_load_dwordx4 v1, s[16:19], s38 offen lds
    s_add_u32 s38, s38, 6272
    s_mov_b32 m0, s39
    s_add_u32 s39, s39, 6384
    buffer_load_dwordx4 v1, s[16:19], s38 offen lds
    s_add_u32 s38, s38, 6272
    s_mov_b32 m0, s39
    s_add_u32 s39, s39, 6384
    buffer_load_dwordx4 v1, s[16:19], s38 offen lds
    s_add_u32 s38, s38, 6272
    s_mov_b32 m0, s39
    s_add_u32 s39, s39, 6384
    buffer_load_dwordx4 v1, s[16:19], s38 offen lds
    s_add_u32 s38, s38, 6272
    s_cmp_ge_u32 s30, 4
    s_cselect_b32 s46, 6272, 0
    s_sub_u32 s38, s38, s46
    s_cselect_b32 s46, 6384, 0
    s_sub_u32 s39, s39, s46
    s_mov_b32 m0, s39
    s_add_u32 s39, s39, 6384
    buffer_load_dwordx4 v1, s[16:19], s38 offen lds
    s_add_u32 s38, s38, 6272
    s_mov_b64 exec, s[50:51]
    s_waitcnt vmcnt(15)
    s_barrier
    s_waitcnt vmcnt(13)
    ds_read_b64_tr_b16 v[64:65], v5 offset:0
    ds_read_b64_tr_b16 v[66:67], v5 offset:1024
    ds_read_b64_tr_b16 v[68:69], v6 offset:0
    ds_read_b64_tr_b16 v[70:71], v6 offset:1024
    ds_read_b128 v[80:83], v1 offset:0
    s_add_u32 s40, s32, 10240
    s_mov_b32 m0, s40
    s_mov_b32 s41, 64512
    buffer_load_dwordx4 v3, s[20:23], s41 offen lds
    s_add_u32 s40, s32, 11264
    s_mov_b32 m0, s40
    s_mov_b32 s41, 71680
    buffer_load_dwordx4 v3, s[20:23], s41 offen lds
    s_waitcnt vmcnt(13)
    s_waitcnt lgkmcnt(0)
    ds_read_b64_tr_b16 v[72:73], v5 offset:2048
    ds_read_b64_tr_b16 v[74:75], v5 offset:3072
    ds_read_b64_tr_b16 v[76:77], v6 offset:2048
    ds_read_b64_tr_b16 v[78:79], v6 offset:3072
    ds_read_b128 v[84:87], v1 offset:1024
    v_mfma_f32_32x32x16_bf16 v[32:47], v[64:67], v[80:83], 0
    v_mfma_f32_32x32x16_bf16 v[48:63], v[68:71], v[80:83], 0
    s_add_u32 s40, s32, 0
    s_mov_b32 m0, s40
    s_mov_b32 s41, 75264
    buffer_load_dwordx4 v3, s[20:23], s41 offen lds
    s_add_u32 s40, s32, 1024
    s_mov_b32 m0, s40
    s_mov_b32 s41, 82432
    buffer_load_dwordx4 v3, s[20:23], s41 offen lds
    s_waitcnt vmcnt(13)
    s_waitcnt lgkmcnt(0)
    ds_read_b64_tr_b16 v[64:65], v5 offset:4096
    ds_read_b64_tr_b16 v[66:67], v5 offset:5120
    ds_read_b64_tr_b16 v[68:69], v6 offset:4096
    ds_read_b64_tr_b16 v[70:71], v6 offset:5120
    ds_read_b128 v[80:83], v1 offset:2048
    v_mfma_f32_32x32x16_bf16 v[32:47], v[72:75], v[84:87], v[32:47]
    v_mfma_f32_32x32x16_bf16 v[48:63], v[76:79], v[84:87], v[48:63]
    s_add_u32 s40, s32, 2048
    s_mov_b32 m0, s40
    s_mov_b32 s41, 89600
    buffer_load_dwordx4 v3, s[20:23], s41 offen lds
    s_add_u32 s40, s32, 3072
    s_mov_b32 m0, s40
    s_mov_b32 s41, 96768
    buffer_load_dwordx4 v3, s[20:23], s41 offen lds
    s_waitcnt vmcnt(13)
    s_waitcnt lgkmcnt(0)
    ds_read_b64_tr_b16 v[72:73], v5 offset:6144
    ds_read_b64_tr_b16 v[74:75], v5 offset:7168
    ds_read_b64_tr_b16 v[76:77], v6 offset:6144
    ds_read_b64_tr_b16 v[78:79], v6 offset:7168
    ds_read_b128 v[84:87], v1 offset:3072
    v_mfma_f32_32x32x16_bf16 v[32:47], v[64:67], v[80:83], v[32:47]
    v_mfma_f32_32x32x16_bf16 v[48:63], v[68:71], v[80:83], v[48:63]
    s_add_u32 s40, s32, 4096
    s_mov_b32 m0, s40
    s_mov_b32 s41, 100352
    buffer_load_dwordx4 v3, s[20:23], s41 offen lds
    s_add_u32 s40, s32, 5120
    s_mov_b32 m0, s40
    s_mov_b32 s41, 107520
    buffer_load_dwordx4 v3, s[20:23], s41 offen lds
    s_waitcnt vmcnt(13)
    s_waitcnt lgkmcnt(0)
    ds_read_b64_tr_b16 v[64:65], v5 offset:8192
    ds_read_b64_tr_b16 v[66:67], v5 offset:9216
    ds_read_b64_tr_b16 v[68:69], v6 offset:8192
    ds_read_b64_tr_b16 v[70:71], v6 offset:9216
    ds_read_b128 v[80:83], v1 offset:4096
    v_mfma_f32_32x32x16_bf16 v[32:47], v[72:75], v[84:87], v[32:47]
    v_mfma_f32_32x32x16_bf16 v[48:63], v[76:79], v[84:87], v[48:63]
    s_add_u32 s40, s32, 6144
    s_mov_b32 m0, s40
    s_mov_b32 s41, 114688
    buffer_load_dwordx4 v3, s[20:23], s41 offen lds
    s_add_u32 s40, s32, 7168
    s_mov_b32 m0, s40
    s_mov_b32 s41, 121856
    buffer_load_dwordx4 v3, s[20:23], s41 offen lds
    s_waitcnt vmcnt(8)
    s_waitcnt lgkmcnt(0)
    ds_read_b64_tr_b16 v[72:73], v5 offset:10240
    ds_read_b64_tr_b16 v[74:75], v5 offset:11264
    ds_read_b64_tr_b16 v[76:77], v6 offset:10240
    ds_read_b64_tr_b16 v[78:79], v6 offset:11264
    ds_read_b128 v[84:87], v1 offset:5120
    v_mfma_f32_32x32x16_bf16 v[32:47], v[64:67], v[80:83], v[32:47]
    v_mfma_f32_32x32x16_bf16 v[48:63], v[68:71], v[80:83], v[48:63]
    s_add_u32 s40, s32, 8192
    s_mov_b32 m0, s40
    s_mov_b32 s41, 125440
    buffer_load_dwordx4 v3, s[20:23], s41 offen lds
    s_add_u32 s40, s32, 9216
    s_mov_b32 m0, s40
    s_mov_b32 s41, 132608
    buffer_load_dwordx4 v3, s[20:23], s41 offen lds
    s_waitcnt vmcnt(8)
    s_waitcnt lgkmcnt(0)
    ds_read_b64_tr_b16 v[64:65], v5 offset:0
    ds_read_b64_tr_b16 v[66:67], v5 offset:1024
    ds_read_b64_tr_b16 v[68:69], v6 offset:0
    ds_read_b64_tr_b16 v[70:71], v6 offset:1024
    ds_read_b128 v[80:83], v1 offset:6144
    v_mfma_f32_32x32x16_bf16 v[32:47], v[72:75], v[84:87], v[32:47]
    v_mfma_f32_32x32x16_bf16 v[48:63], v[76:79], v[84:87], v[48:63]
    s_add_u32 s40, s32, 10240
    s_mov_b32 m0, s40
    s_mov_b32 s41, 139776
    buffer_load_dwordx4 v3, s[20:23], s41 offen lds
    s_add_u32 s40, s32, 11264
    s_mov_b32 m0, s40
    s_mov_b32 s41, 146944
    buffer_load_dwordx4 v3, s[20:23], s41 offen lds
    s_waitcnt vmcnt(8)
    s_waitcnt lgkmcnt(0)
    ds_read_b64_tr_b16 v[72:73], v5 offset:2048
    ds_read_b64_tr_b16 v[74:75], v5 offset:3072
    ds_read_b64_tr_b16 v[76:77], v6 offset:2048
    ds_read_b64_tr_b16 v[78:79], v6 offset:3072
    ds_read_b128 v[84:87], v1 offset:7168
    v_mfma_f32_32x32x16_bf16 v[32:47], v[64:67], v[80:83], v[32:47]
    v_mfma_f32_32x32x16_bf16 v[48:63], v[68:71], v[80:83], v[48:63]
    s_add_u32 s40, s32, 0
    s_mov_b32 m0, s40
    s_mov_b32 s41, 150528
    buffer_load_dwordx4 v3, s[20:23], s41 offen lds
    s_add_u32 s40, s32, 1024
    s_mov_b32 m0, s40
    s_mov_b32 s41, 157696
    buffer_load_dwordx4 v3, s[20:23], s41 offen lds
    s_waitcnt vmcnt(8)
    s_waitcnt lgkmcnt(0)
    ds_read_b64_tr_b16 v[64:65], v5 offset:4096
    ds_read_b64_tr_b16 v[66:67], v5 offset:5120
    ds_read_b64_tr_b16 v[68:69], v6 offset:4096
    ds_read_b64_tr_b16 v[70:71], v6 offset:5120
    ds_read_b128 v[80:83], v1 offset:8192
    v_mfma_f32_32x32x16_bf16 v[32:47], v[72:75], v[84:87], v[32:47]
    v_mfma_f32_32x32x16_bf16 v[48:63], v[76:79], v[84:87], v[48:63]
    s_add_u32 s40, s32, 2048
    s_mov_b32 m0, s40
    s_mov_b32 s41, 164864
    buffer_load_dwordx4 v3, s[20:23], s41 offen lds
    s_add_u32 s40, s32, 3072
    s_mov_b32 m0, s40
    s_mov_b32 s41, 172032
    buffer_load_dwordx4 v3, s[20:23], s41 offen lds
    s_waitcnt vmcnt(8)
    s_waitcnt lgkmcnt(0)
    ds_read_b64_tr_b16 v[72:73], v5 offset:6144
    ds_read_b64_tr_b16 v[74:75], v5 offset:7168
    ds_read_b64_tr_b16 v[76:77], v6 offset:6144
    ds_read_b64_tr_b16 v[78:79], v6 offset:7168
    ds_read_b128 v[84:87], v1 offset:9216
    v_mfma_f32_32x32x16_bf16 v[32:47], v[64:67], v[80:83], v[32:47]
    v_mfma_f32_32x32x16_bf16 v[48:63], v[68:71], v[80:83], v[48:63]
    s_add_u32 s40, s32, 4096
    s_mov_b32 m0, s40
    s_mov_b32 s41, 175616
    buffer_load_dwordx4 v3, s[20:23], s41 offen lds
    s_add_u32 s40, s32, 5120
    s_mov_b32 m0, s40
    s_mov_b32 s41, 182784
    buffer_load_dwordx4 v3, s[20:23], s41 offen lds
    s_waitcnt vmcnt(8)
    s_waitcnt lgkmcnt(0)
    ds_read_b64_tr_b16 v[64:65], v5 offset:8192
    ds_read_b64_tr_b16 v[66:67], v5 offset:9216
    ds_read_b64_tr_b16 v[68:69], v6 offset:8192
    ds_read_b64_tr_b16 v[70:71], v6 offset:9216
    ds_read_b128 v[80:83], v1 offset:10240
    v_mfma_f32_32x32x16_bf16 v[32:47], v[72:75], v[84:87], v[32:47]
    v_mfma_f32_32x32x16_bf16 v[48:63], v[76:79], v[84:87], v[48:63]
    s_add_u32 s40, s32, 6144
    s_mov_b32 m0, s40
    s_mov_b32 s41, 189952
    buffer_load_dwordx4 v3, s[20:23], s41 offen lds
    s_add_u32 s40, s32, 7168
    s_mov_b32 m0, s40
    s_mov_b32 s41, 197120
    buffer_load_dwordx4 v3, s[20:23], s41 offen lds
    s_waitcnt vmcnt(8)
    s_waitcnt lgkmcnt(0)
    ds_read_b64_tr_b16 v[72:73], v5 offset:10240
    ds_read_b64_tr_b16 v[74:75], v5 offset:11264
    ds_read_b64_tr_b16 v[76:77], v6 offset:10240
    ds_read_b64_tr_b16 v[78:79], v6 offset:11264
    ds_read_b128 v[84:87], v1 offset:11264
    v_mfma_f32_32x32x16_bf16 v[32:47], v[64:67], v[80:83], v[32:47]
    v_mfma_f32_32x32x16_bf16 v[48:63], v[68:71], v[80:83], v[48:63]
    s_add_u32 s40, s32, 8192
    s_mov_b32 m0, s40
    s_mov_b32 s41, 200704
    buffer_load_dwordx4 v3, s[20:23], s41 offen lds
    s_add_u32 s40, s32, 9216
    s_mov_b32 m0, s40
    s_mov_b32 s41, 207872
    buffer_load_dwordx4 v3, s[20:23], s41 offen lds
    s_waitcnt vmcnt(8)
    s_waitcnt lgkmcnt(0)
    ds_read_b64_tr_b16 v[64:65], v5 offset:0
    ds_read_b64_tr_b16 v[66:67], v5 offset:1024
    ds_read_b64_tr_b16 v[68:69], v6 offset:0
    ds_read_b64_tr_b16 v[70:71], v6 offset:1024
    ds_read_b128 v[80:83], v1 offset:12288
    v_mfma_f32_32x32x16_bf16 v[32:47], v[72:75], v[84:87], v[32:47]
    v_mfma_f32_32x32x16_bf16 v[48:63], v[76:79], v[84:87], v[48:63]
    s_add_u32 s40, s32, 10240
    s_mov_b32 m0, s40
    s_mov_b32 s41, 215040
    buffer_load_dwordx4 v3, s[20:23], s41 offen lds
    s_add_u32 s40, s32, 11264
    s_mov_b32 m0, s40
    s_mov_b32 s41, 222208
    buffer_load_dwordx4 v3, s[20:23], s41 offen lds
    s_waitcnt vmcnt(8)
    s_waitcnt lgkmcnt(0)
    ds_read_b64_tr_b16 v[72:73], v5 offset:2048
    ds_read_b64_tr_b16 v[74:75], v5 offset:3072
    ds_read_b64_tr_b16 v[76:77], v6 offset:2048
    ds_read_b64_tr_b16 v[78:79], v6 offset:3072
    ds_read_b128 v[84:87], v1 offset:13312
    v_mfma_f32_32x32x16_bf16 v[32:47], v[64:67], v[80:83], v[32:47]
    v_mfma_f32_32x32x16_bf16 v[48:63], v[68:71], v[80:83], v[48:63]
    s_add_u32 s40, s32, 0
    s_mov_b32 m0, s40
    s_mov_b32 s41, 225792
    buffer_load_dwordx4 v3, s[20:23], s41 offen lds
    s_add_u32 s40, s32, 1024
    s_mov_b32 m0, s40
    s_mov_b32 s41, 232960
    buffer_load_dwordx4 v3, s[20:23], s41 offen lds
    s_waitcnt vmcnt(8)
    s_waitcnt lgkmcnt(0)
    ds_read_b64_tr_b16 v[64:65], v5 offset:4096
    ds_read_b64_tr_b16 v[66:67], v5 offset:5120
    ds_read_b64_tr_b16 v[68:69], v6 offset:4096
    ds_read_b64_tr_b16 v[70:71], v6 offset:5120
    ds_read_b128 v[80:83], v1 offset:14336
    v_mfma_f32_32x32x16_bf16 v[32:47], v[72:75], v[84:87], v[32:47]
    v_mfma_f32_32x32x16_bf16 v[48:63], v[76:79], v[84:87], v[48:63]
    s_add_u32 s40, s32, 2048
    s_mov_b32 m0, s40
    s_mov_b32 s41, 240128
    buffer_load_dwordx4 v3, s[20:23], s41 offen lds
    s_add_u32 s40, s32, 3072
    s_mov_b32 m0, s40
    s_mov_b32 s41, 247296
    buffer_load_dwordx4 v3, s[20:23], s41 offen lds
    s_waitcnt vmcnt(8)
    s_waitcnt lgkmcnt(0)
    ds_read_b64_tr_b16 v[72:73], v5 offset:6144
    ds_read_b64_tr_b16 v[74:75], v5 offset:7168
    ds_read_b64_tr_b16 v[76:77], v6 offset:6144
    ds_read_b64_tr_b16 v[78:79], v6 offset:7168
    ds_read_b128 v[84:87], v1 offset:15360
    v_mfma_f32_32x32x16_bf16 v[32:47], v[64:67], v[80:83], v[32:47]
    v_mfma_f32_32x32x16_bf16 v[48:63], v[68:71], v[80:83], v[48:63]
    s_add_u32 s40, s32, 4096
    s_mov_b32 m0, s40
    s_mov_b32 s41, 250880
    buffer_load_dwordx4 v3, s[20:23], s41 offen lds
    s_add_u32 s40, s32, 5120
    s_mov_b32 m0, s40
    s_mov_b32 s41, 258048
    buffer_load_dwordx4 v3, s[20:23], s41 offen lds
    s_waitcnt vmcnt(8)
    s_waitcnt lgkmcnt(0)
    ds_read_b64_tr_b16 v[64:65], v5 offset:8192
    ds_read_b64_tr_b16 v[66:67], v5 offset:9216
    ds_read_b64_tr_b16 v[68:69], v6 offset:8192
    ds_read_b64_tr_b16 v[70:71], v6 offset:9216
    ds_read_b128 v[80:83], v1 offset:16384
    v_mfma_f32_32x32x16_bf16 v[32:47], v[72:75], v[84:87], v[32:47]
    v_mfma_f32_32x32x16_bf16 v[48:63], v[76:79], v[84:87], v[48:63]
    s_add_u32 s40, s32, 6144
    s_mov_b32 m0, s40
    s_mov_b32 s41, 265216
    buffer_load_dwordx4 v3, s[20:23], s41 offen lds
    s_add_u32 s40, s32, 7168
    s_mov_b32 m0, s40
    s_mov_b32 s41, 272384
    buffer_load_dwordx4 v3, s[20:23], s41 offen lds
    s_waitcnt vmcnt(8)
    s_waitcnt lgkmcnt(0)
    ds_read_b64_tr_b16 v[72:73], v5 offset:10240
    ds_read_b64_tr_b16 v[74:75], v5 offset:11264
    ds_read_b64_tr_b16 v[76:77], v6 offset:10240
    ds_read_b64_tr_b16 v[78:79], v6 offset:11264
    ds_read_b128 v[84:87], v1 offset:17408
    v_mfma_f32_32x32x16_bf16 v[32:47], v[64:67], v[80:83], v[32:47]
    v_mfma_f32_32x32x16_bf16 v[48:63], v[68:71], v[80:83], v[48:63]
    s_add_u32 s40, s32, 8192
    s_mov_b32 m0, s40
    s_mov_b32 s41, 275968
    buffer_load_dwordx4 v3, s[20:23], s41 offen lds
    s_add_u32 s40, s32, 9216
    s_mov_b32 m0, s40
    s_mov_b32 s41, 283136
    buffer_load_dwordx4 v3, s[20:23], s41 offen lds
    s_waitcnt vmcnt(8)
    s_waitcnt lgkmcnt(0)
    ds_read_b64_tr_b16 v[64:65], v5 offset:0
    ds_read_b64_tr_b16 v[66:67], v5 offset:1024
    ds_read_b64_tr_b16 v[68:69], v6 offset:0
    ds_read_b64_tr_b16 v[70:71], v6 offset:1024
    ds_read_b128 v[80:83], v1 offset:18432
    v_mfma_f32_32x32x16_bf16 v[32:47], v[72:75], v[84:87], v[32:47]
    v_mfma_f32_32x32x16_bf16 v[48:63], v[76:79], v[84:87], v[48:63]
    s_add_u32 s40, s32, 10240
    s_mov_b32 m0, s40
    s_mov_b32 s41, 290304
    buffer_load_dwordx4 v3, s[20:23], s41 offen lds
    s_add_u32 s40, s32, 11264
    s_mov_b32 m0, s40
    s_mov_b32 s41, 297472
    buffer_load_dwordx4 v3, s[20:23], s41 offen lds
    s_waitcnt vmcnt(8)
    s_waitcnt lgkmcnt(0)
    ds_read_b64_tr_b16 v[72:73], v5 offset:2048
    ds_read_b64_tr_b16 v[74:75], v5 offset:3072
    ds_read_b64_tr_b16 v[76:77], v6 offset:2048
    ds_read_b64_tr_b16 v[78:79], v6 offset:3072
    ds_read_b128 v[84:87], v1 offset:19456
    v_mfma_f32_32x32x16_bf16 v[32:47], v[64:67], v[80:83], v[32:47]
    v_mfma_f32_32x32x16_bf16 v[48:63], v[68:71], v[80:83], v[48:63]
    s_add_u32 s40, s32, 0
    s_mov_b32 m0, s40
    s_mov_b32 s41, 301056
    buffer_load_dwordx4 v3, s[20:23], s41 offen lds
    s_add_u32 s40, s32, 1024
    s_mov_b32 m0, s40
    s_mov_b32 s41, 308224
    buffer_load_dwordx4 v3, s[20:23], s41 offen lds
    s_waitcnt vmcnt(8)
    s_waitcnt lgkmcnt(0)
    ds_read_b64_tr_b16 v[64:65], v5 offset:4096
    ds_read_b64_tr_b16 v[66:67], v5 offset:5120
    ds_read_b64_tr_b16 v[68:69], v6 offset:4096
    ds_read_b64_tr_b16 v[70:71], v6 offset:5120
    ds_read_b128 v[80:83], v1 offset:20480
    v_mfma_f32_32x32x16_bf16 v[32:47], v[72:75], v[84:87], v[32:47]
    v_mfma_f32_32x32x16_bf16 v[48:63], v[76:79], v[84:87], v[48:63]
    s_add_u32 s40, s32, 2048
    s_mov_b32 m0, s40
    s_mov_b32 s41, 315392
    buffer_load_dwordx4 v3, s[20:23], s41 offen lds
    s_add_u32 s40, s32, 3072
    s_mov_b32 m0, s40
    s_mov_b32 s41, 322560
    buffer_load_dwordx4 v3, s[20:23], s41 offen lds
    s_waitcnt vmcnt(8)
    s_waitcnt lgkmcnt(0)
    ds_read_b64_tr_b16 v[72:73], v5 offset:6144
    ds_read_b64_tr_b16 v[74:75], v5 offset:7168
    ds_read_b64_tr_b16 v[76:77], v6 offset:6144
    ds_read_b64_tr_b16 v[78:79], v6 offset:7168
    ds_read_b128 v[84:87], v1 offset:21504
    v_mfma_f32_32x32x16_bf16 v[32:47], v[64:67], v[80:83], v[32:47]
    v_mfma_f32_32x32x16_bf16 v[48:63], v[68:71], v[80:83], v[48:63]
    s_add_u32 s40, s32, 4096
    s_mov_b32 m0, s40
    s_mov_b32 s41, 326144
    buffer_load_dwordx4 v3, s[20:23], s41 offen lds
    s_add_u32 s40, s32, 5120
    s_mov_b32 m0, s40
    s_mov_b32 s41, 333312
    buffer_load_dwordx4 v3, s[20:23], s41 offen lds
    s_waitcnt vmcnt(8)
    s_waitcnt lgkmcnt(0)
    ds_read_b64_tr_b16 v[64:65], v5 offset:8192
    ds_read_b64_tr_b16 v[66:67], v5 offset:9216
    ds_read_b64_tr_b16 v[68:69], v6 offset:8192
    ds_read_b64_tr_b16 v[70:71], v6 offset:9216
    ds_read_b128 v[80:83], v1 offset:22528
    v_mfma_f32_32x32x16_bf16 v[32:47], v[72:75], v[84:87], v[32:47]
    v_mfma_f32_32x32x16_bf16 v[48:63], v[76:79], v[84:87], v[48:63]
    s_add_u32 s40, s32, 6144
    s_mov_b32 m0, s40
    s_mov_b32 s41, 340480
    buffer_load_dwordx4 v3, s[20:23], s41 offen lds
    s_add_u32 s40, s32, 7168
    s_mov_b32 m0, s40
    s_mov_b32 s41, 347648
    buffer_load_dwordx4 v3, s[20:23], s41 offen lds
    s_waitcnt vmcnt(8)
    s_waitcnt lgkmcnt(0)
    ds_read_b64_tr_b16 v[72:73], v5 offset:10240
    ds_read_b64_tr_b16 v[74:75], v5 offset:11264
    ds_read_b64_tr_b16 v[76:77], v6 offset:10240
    ds_read_b64_tr_b16 v[78:79], v6 offset:11264
    ds_read_b128 v[84:87], v1 offset:23552
    v_mfma_f32_32x32x16_bf16 v[32:47], v[64:67], v[80:83], v[32:47]
    v_mfma_f32_32x32x16_bf16 v[48:63], v[68:71], v[80:83], v[48:63]
    s_add_u32 s40, s32, 8192
    s_mov_b32 m0, s40
    s_mov_b32 s41, 351232
    buffer_load_dwordx4 v3, s[20:23], s41 offen lds
    s_add_u32 s40, s32, 9216
    s_mov_b32 m0, s40
    s_mov_b32 s41, 358400
    buffer_load_dwordx4 v3, s[20:23], s41 offen lds
    s_waitcnt vmcnt(8)
    s_waitcnt lgkmcnt(0)
    ds_read_b64_tr_b16 v[64:65], v5 offset:0
    ds_read_b64_tr_b16 v[66:67], v5 offset:1024
    ds_read_b64_tr_b16 v[68:69], v6 offset:0
    ds_read_b64_tr_b16 v[70:71], v6 offset:1024
    ds_read_b128 v[80:83], v1 offset:24576
    v_mfma_f32_32x32x16_bf16 v[32:47], v[72:75], v[84:87], v[32:47]
    v_mfma_f32_32x32x16_bf16 v[48:63], v[76:79], v[84:87], v[48:63]
    s_add_u32 s40, s32, 10240
    s_mov_b32 m0, s40
    s_mov_b32 s41, 365568
    buffer_load_dwordx4 v3, s[20:23], s41 offen lds
    s_add_u32 s40, s32, 11264
    s_mov_b32 m0, s40
    s_mov_b32 s41, 372736
    buffer_load_dwordx4 v3, s[20:23], s41 offen lds
    s_waitcnt vmcnt(8)
    s_waitcnt lgkmcnt(0)
    ds_read_b64_tr_b16 v[72:73], v5 offset:2048
    ds_read_b64_tr_b16 v[74:75], v5 offset:3072
    ds_read_b64_tr_b16 v[76:77], v6 offset:2048
    ds_read_b64_tr_b16 v[78:79], v6 offset:3072
    ds_read_b128 v[84:87], v1 offset:25600
    v_mfma_f32_32x32x16_bf16 v[32:47], v[64:67], v[80:83], v[32:47]
    v_mfma_f32_32x32x16_bf16 v[48:63], v[68:71], v[80:83], v[48:63]
    s_add_u32 s40, s32, 0
    s_mov_b32 m0, s40
    s_mov_b32 s41, 376320
    buffer_load_dwordx4 v3, s[20:23], s41 offen lds
    s_add_u32 s40, s32, 1024
    s_mov_b32 m0, s40
    s_mov_b32 s41, 383488
    buffer_load_dwordx4 v3, s[20:23], s41 offen lds
    s_waitcnt vmcnt(8)
    s_waitcnt lgkmcnt(0)
    ds_read_b64_tr_b16 v[64:65], v5 offset:4096
    ds_read_b64_tr_b16 v[66:67], v5 offset:5120
    ds_read_b64_tr_b16 v[68:69], v6 offset:4096
    ds_read_b64_tr_b16 v[70:71], v6 offset:5120
    ds_read_b128 v[80:83], v1 offset:26624
    v_mfma_f32_32x32x16_bf16 v[32:47], v[72:75], v[84:87], v[32:47]
    v_mfma_f32_32x32x16_bf16 v[48:63], v[76:79], v[84:87], v[48:63]
    s_add_u32 s40, s32, 2048
    s_mov_b32 m0, s40
    s_mov_b32 s41, 390656
    buffer_load_dwordx4 v3, s[20:23], s41 offen lds
    s_add_u32 s40, s32, 3072
    s_mov_b32 m0, s40
    s_mov_b32 s41, 397824
    buffer_load_dwordx4 v3, s[20:23], s41 offen lds
    s_waitcnt vmcnt(8)
    s_waitcnt lgkmcnt(0)
    ds_read_b64_tr_b16 v[72:73], v5 offset:6144
    ds_read_b64_tr_b16 v[74:75], v5 offset:7168
    ds_read_b64_tr_b16 v[76:77], v6 offset:6144
    ds_read_b64_tr_b16 v[78:79], v6 offset:7168
    ds_read_b128 v[84:87], v1 offset:27648
    v_mfma_f32_32x32x16_bf16 v[32:47], v[64:67], v[80:83], v[32:47]
    v_mfma_f32_32x32x16_bf16 v[48:63], v[68:71], v[80:83], v[48:63]
    s_waitcnt vmcnt(6)
    s_waitcnt lgkmcnt(0)
    ds_read_b64_tr_b16 v[64:65], v5 offset:8192
    ds_read_b64_tr_b16 v[66:67], v5 offset:9216
    ds_read_b64_tr_b16 v[68:69], v6 offset:8192
    ds_read_b64_tr_b16 v[70:71], v6 offset:9216
    ds_read_b128 v[80:83], v1 offset:28672
    v_mfma_f32_32x32x16_bf16 v[32:47], v[72:75], v[84:87], v[32:47]
    v_mfma_f32_32x32x16_bf16 v[48:63], v[76:79], v[84:87], v[48:63]
    s_waitcnt vmcnt(4)
    s_waitcnt lgkmcnt(0)
    ds_read_b64_tr_b16 v[72:73], v5 offset:10240
    ds_read_b64_tr_b16 v[74:75], v5 offset:11264
    ds_read_b64_tr_b16 v[76:77], v6 offset:10240
    ds_read_b64_tr_b16 v[78:79], v6 offset:11264
    ds_read_b128 v[84:87], v1 offset:29696
    v_mfma_f32_32x32x16_bf16 v[32:47], v[64:67], v[80:83], v[32:47]
    v_mfma_f32_32x32x16_bf16 v[48:63], v[68:71], v[80:83], v[48:63]
    s_waitcnt vmcnt(2)
    s_waitcnt lgkmcnt(0)
    ds_read_b64_tr_b16 v[64:65], v5 offset:0
    ds_read_b64_tr_b16 v[66:67], v5 offset:1024
    ds_read_b64_tr_b16 v[68:69], v6 offset:0
    ds_read_b64_tr_b16 v[70:71], v6 offset:1024
    ds_read_b128 v[80:83], v1 offset:30720
    v_mfma_f32_32x32x16_bf16 v[32:47], v[72:75], v[84:87], v[32:47]
    v_mfma_f32_32x32x16_bf16 v[48:63], v[76:79], v[84:87], v[48:63]
    s_waitcnt vmcnt(0)
    s_waitcnt lgkmcnt(0)
    ds_read_b64_tr_b16 v[72:73], v5 offset:2048
    ds_read_b64_tr_b16 v[74:75], v5 offset:3072
    ds_read_b64_tr_b16 v[76:77], v6 offset:2048
    ds_read_b64_tr_b16 v[78:79], v6 offset:3072
    ds_read_b128 v[84:87], v1 offset:31744
    v_mfma_f32_32x32x16_bf16 v[32:47], v[64:67], v[80:83], v[32:47]
    v_mfma_f32_32x32x16_bf16 v[48:63], v[68:71], v[80:83], v[48:63]
    s_waitcnt lgkmcnt(0)
    v_mfma_f32_32x32x16_bf16 v[32:47], v[72:75], v[84:87], v[32:47]
    v_mfma_f32_32x32x16_bf16 v[48:63], v[76:79], v[84:87], v[48:63]
    s_waitcnt vmcnt(0)
    s_barrier
    v_and_b32 v9, 31, v2
    s_movk_i32 s42, 912
    v_mul_lo_u32 v9, v9, s42
    v_lshrrev_b32 v10, 5, v2
    v_lshl_add_u32 v9, v10, 3, v9
    v_add_u32 v9, s33, v9
    v_add_u32 v9, 118784, v9
    ds_read_b64 v[96:97], v9 offset:0
    ds_read_b64 v[98:99], v9 offset:16
    ds_read_b64 v[100:101], v9 offset:32
    ds_read_b64 v[102:103], v9 offset:48
    ds_read_b64 v[104:105], v9 offset:64
    ds_read_b64 v[106:107], v9 offset:80
    ds_read_b64 v[108:109], v9 offset:96
    ds_read_b64 v[110:111], v9 offset:112
    v_cvt_pk_bf16_f32 v112, v32, v33
    v_cvt_pk_bf16_f32 v113, v34, v35
    v_cvt_pk_bf16_f32 v114, v36, v37
    v_cvt_pk_bf16_f32 v115, v38, v39
    v_cvt_pk_bf16_f32 v116, v40, v41
    v_cvt_pk_bf16_f32 v117, v42, v43
    v_cvt_pk_bf16_f32 v118, v44, v45
    v_cvt_pk_bf16_f32 v119, v46, v47
    v_cvt_pk_bf16_f32 v120, v48, v49
    v_cvt_pk_bf16_f32 v121, v50, v51
    v_cvt_pk_bf16_f32 v122, v52, v53
    v_cvt_pk_bf16_f32 v123, v54, v55
    v_cvt_pk_bf16_f32 v124, v56, v57
    v_cvt_pk_bf16_f32 v125, v58, v59
    v_cvt_pk_bf16_f32 v126, v60, v61
    v_cvt_pk_bf16_f32 v127, v62, v63
    s_waitcnt lgkmcnt(0)
    v_lshlrev_b32 v32, 16, v112
    v_and_b32 v33, 0xffff0000, v112
    v_lshlrev_b32 v64, 16, v96
    v_and_b32 v65, 0xffff0000, v96
    v_lshlrev_b32 v34, 16, v113
    v_and_b32 v35, 0xffff0000, v113
    v_lshlrev_b32 v66, 16, v97
    v_and_b32 v67, 0xffff0000, v97
    v_lshlrev_b32 v36, 16, v114
    v_and_b32 v37, 0xffff0000, v114
    v_lshlrev_b32 v68, 16, v98
    v_and_b32 v69, 0xffff0000, v98
    v_lshlrev_b32 v38, 16, v115
    v_and_b32 v39, 0xffff0000, v115
    v_lshlrev_b32 v70, 16, v99
    v_and_b32 v71, 0xffff0000, v99
    v_lshlrev_b32 v40, 16, v116
    v_and_b32 v41, 0xffff0000, v116
    v_lshlrev_b32 v72, 16, v100
    v_and_b32 v73, 0xffff0000, v100
    v_lshlrev_b32 v42, 16, v117
    v_and_b32 v43, 0xffff0000, v117
    v_lshlrev_b32 v74, 16, v101
    v_and_b32 v75, 0xffff0000, v101
    v_lshlrev_b32 v44, 16, v118
    v_and_b32 v45, 0xffff0000, v118
    v_lshlrev_b32 v76, 16, v102
    v_and_b32 v77, 0xffff0000, v102
    v_lshlrev_b32 v46, 16, v119
    v_and_b32 v47, 0xffff0000, v119
    v_lshlrev_b32 v78, 16, v103
    v_and_b32 v79, 0xffff0000, v103
    v_lshlrev_b32 v48, 16, v120
    v_and_b32 v49, 0xffff0000, v120
    v_lshlrev_b32 v80, 16, v104
    v_and_b32 v81, 0xffff0000, v104
    v_lshlrev_b32 v50, 16, v121
    v_and_b32 v51, 0xffff0000, v121
    v_lshlrev_b32 v82, 16, v105
    v_and_b32 v83, 0xffff0000, v105
    v_lshlrev_b32 v52, 16, v122
    v_and_b32 v53, 0xffff0000, v122
    v_lshlrev_b32 v84, 16, v106
    v_and_b32 v85, 0xffff0000, v106
    v_lshlrev_b32 v54, 16, v123
    v_and_b32 v55, 0xffff0000, v123
    v_lshlrev_b32 v86, 16, v107
    v_and_b32 v87, 0xffff0000, v107
    v_lshlrev_b32 v56, 16, v124
    v_and_b32 v57, 0xffff0000, v124
    v_lshlrev_b32 v88, 16, v108
    v_and_b32 v89, 0xffff0000, v108
    v_lshlrev_b32 v58, 16, v125
    v_and_b32 v59, 0xffff0000, v125
    v_lshlrev_b32 v90, 16, v109
    v_and_b32 v91, 0xffff0000, v109
    v_lshlrev_b32 v60, 16, v126
    v_and_b32 v61, 0xffff0000, v126
    v_lshlrev_b32 v92, 16, v110
    v_and_b32 v93, 0xffff0000, v110
    v_lshlrev_b32 v62, 16, v127
    v_and_b32 v63, 0xffff0000, v127
    v_lshlrev_b32 v94, 16, v111
    v_and_b32 v95, 0xffff0000, v111
    v_pk_add_f32 v[32:33], v[32:33], v[64:65]
    v_pk_add_f32 v[34:35], v[34:35], v[66:67]
    v_pk_add_f32 v[36:37], v[36:37], v[68:69]
    v_pk_add_f32 v[38:39], v[38:39], v[70:71]
    v_pk_add_f32 v[40:41], v[40:41], v[72:73]
    v_pk_add_f32 v[42:43], v[42:43], v[74:75]
    v_pk_add_f32 v[44:45], v[44:45], v[76:77]
    v_pk_add_f32 v[46:47], v[46:47], v[78:79]
    v_pk_add_f32 v[48:49], v[48:49], v[80:81]
    v_pk_add_f32 v[50:51], v[50:51], v[82:83]
    v_pk_add_f32 v[52:53], v[52:53], v[84:85]
    v_pk_add_f32 v[54:55], v[54:55], v[86:87]
    v_pk_add_f32 v[56:57], v[56:57], v[88:89]
    v_pk_add_f32 v[58:59], v[58:59], v[90:91]
    v_pk_add_f32 v[60:61], v[60:61], v[92:93]
    v_pk_add_f32 v[62:63], v[62:63], v[94:95]
    v_cvt_pk_bf16_f32 v112, v32, v33
    v_cvt_pk_bf16_f32 v113, v34, v35
    v_cvt_pk_bf16_f32 v114, v36, v37
    v_cvt_pk_bf16_f32 v115, v38, v39
    v_cvt_pk_bf16_f32 v116, v40, v41
    v_cvt_pk_bf16_f32 v117, v42, v43
    v_cvt_pk_bf16_f32 v118, v44, v45
    v_cvt_pk_bf16_f32 v119, v46, v47
    v_cvt_pk_bf16_f32 v120, v48, v49
    v_cvt_pk_bf16_f32 v121, v50, v51
    v_cvt_pk_bf16_f32 v122, v52, v53
    v_cvt_pk_bf16_f32 v123, v54, v55
    v_cvt_pk_bf16_f32 v124, v56, v57
    v_cvt_pk_bf16_f32 v125, v58, v59
    v_cvt_pk_bf16_f32 v126, v60, v61
    v_cvt_pk_bf16_f32 v127, v62, v63
    s_mul_i32 s43, s2, 14
    s_lshl_b32 s44, s30, 1
    s_add_u32 s43, s43, s44
    s_lshl_b32 s43, s43, 11
    s_add_u32 s43, s43, 4456448
    buffer_store_dwordx4 v[112:115], v1, s[24:27], s43 offen offset:0
    buffer_store_dwordx4 v[116:119], v1, s[24:27], s43 offen offset:1024
    buffer_store_dwordx4 v[120:123], v1, s[24:27], s43 offen offset:2048
    buffer_store_dwordx4 v[124:127], v1, s[24:27], s43 offen offset:3072
    v_lshlrev_b32 v32, 16, v112
    v_and_b32 v33, 0xffff0000, v112
    v_lshlrev_b32 v34, 16, v113
    v_and_b32 v35, 0xffff0000, v113
    v_lshlrev_b32 v36, 16, v114
    v_and_b32 v37, 0xffff0000, v114
    v_lshlrev_b32 v38, 16, v115
    v_and_b32 v39, 0xffff0000, v115
    v_lshlrev_b32 v40, 16, v116
    v_and_b32 v41, 0xffff0000, v116
    v_lshlrev_b32 v42, 16, v117
    v_and_b32 v43, 0xffff0000, v117
    v_lshlrev_b32 v44, 16, v118
    v_and_b32 v45, 0xffff0000, v118
    v_lshlrev_b32 v46, 16, v119
    v_and_b32 v47, 0xffff0000, v119
    v_lshlrev_b32 v48, 16, v120
    v_and_b32 v49, 0xffff0000, v120
    v_lshlrev_b32 v50, 16, v121
    v_and_b32 v51, 0xffff0000, v121
    v_lshlrev_b32 v52, 16, v122
    v_and_b32 v53, 0xffff0000, v122
    v_lshlrev_b32 v54, 16, v123
    v_and_b32 v55, 0xffff0000, v123
    v_lshlrev_b32 v56, 16, v124
    v_and_b32 v57, 0xffff0000, v124
    v_lshlrev_b32 v58, 16, v125
    v_and_b32 v59, 0xffff0000, v125
    v_lshlrev_b32 v60, 16, v126
    v_and_b32 v61, 0xffff0000, v126
    v_lshlrev_b32 v62, 16, v127
    v_and_b32 v63, 0xffff0000, v127
    v_pk_add_f32 v[12:13], v[32:33], v[34:35]
    v_pk_mul_f32 v[16:17], v[32:33], v[32:33]
    v_pk_fma_f32 v[16:17], v[34:35], v[34:35], v[16:17]
    v_pk_add_f32 v[12:13], v[12:13], v[36:37]
    v_pk_fma_f32 v[16:17], v[36:37], v[36:37], v[16:17]
    v_pk_add_f32 v[12:13], v[12:13], v[38:39]
    v_pk_fma_f32 v[16:17], v[38:39], v[38:39], v[16:17]
    v_pk_add_f32 v[12:13], v[12:13], v[40:41]
    v_pk_fma_f32 v[16:17], v[40:41], v[40:41], v[16:17]
    v_pk_add_f32 v[12:13], v[12:13], v[42:43]
    v_pk_fma_f32 v[16:17], v[42:43], v[42:43], v[16:17]
    v_pk_add_f32 v[12:13], v[12:13], v[44:45]
    v_pk_fma_f32 v[16:17], v[44:45], v[44:45], v[16:17]
    v_pk_add_f32 v[12:13], v[12:13], v[46:47]
    v_pk_fma_f32 v[16:17], v[46:47], v[46:47], v[16:17]
    v_pk_add_f32 v[12:13], v[12:13], v[48:49]
    v_pk_fma_f32 v[16:17], v[48:49], v[48:49], v[16:17]
    v_pk_add_f32 v[12:13], v[12:13], v[50:51]
    v_pk_fma_f32 v[16:17], v[50:51], v[50:51], v[16:17]
    v_pk_add_f32 v[12:13], v[12:13], v[52:53]
    v_pk_fma_f32 v[16:17], v[52:53], v[52:53], v[16:17]
    v_pk_add_f32 v[12:13], v[12:13], v[54:55]
    v_pk_fma_f32 v[16:17], v[54:55], v[54:55], v[16:17]
    v_pk_add_f32 v[12:13], v[12:13], v[56:57]
    v_pk_fma_f32 v[16:17], v[56:57], v[56:57], v[16:17]
    v_pk_add_f32 v[12:13], v[12:13], v[58:59]
    v_pk_fma_f32 v[16:17], v[58:59], v[58:59], v[16:17]
    v_pk_add_f32 v[12:13], v[12:13], v[60:61]
    v_pk_fma_f32 v[16:17], v[60:61], v[60:61], v[16:17]
    v_pk_add_f32 v[12:13], v[12:13], v[62:63]
    v_pk_fma_f32 v[16:17], v[62:63], v[62:63], v[16:17]
    v_add_f32 v12, v12, v13
    v_add_f32 v16, v16, v17
    v_mov_b32 v13, v12
    v_mov_b32 v17, v16
    s_nop 1
    v_permlane32_swap_b32 v12, v13
    v_permlane32_swap_b32 v16, v17
    v_add_f32 v12, v12, v13
    v_add_f32 v13, v16, v17
    v_and_b32 v14, 31, v2
    v_lshlrev_b32 v14, 3, v14
    v_add_u32 v14, 147968, v14
    s_lshl_b32 s46, s30, 8
    v_add_u32 v15, s46, v14
    ds_write_b64 v15, v[12:13]
    s_waitcnt lgkmcnt(0)
    s_barrier
    ds_read_b64 v[16:17], v14 offset:0
    ds_read_b64 v[18:19], v14 offset:256
    ds_read_b64 v[20:21], v14 offset:512
    ds_read_b64 v[22:23], v14 offset:768
    ds_read_b64 v[24:25], v14 offset:1024
    ds_read_b64 v[26:27], v14 offset:1280
    ds_read_b64 v[28:29], v14 offset:1536
    s_waitcnt lgkmcnt(0)
    v_pk_add_f32 v[12:13], v[16:17], v[18:19]
    v_pk_add_f32 v[12:13], v[12:13], v[20:21]
    v_pk_add_f32 v[12:13], v[12:13], v[22:23]
    v_pk_add_f32 v[12:13], v[12:13], v[24:25]
    v_pk_add_f32 v[12:13], v[12:13], v[26:27]
    v_pk_add_f32 v[12:13], v[12:13], v[28:29]
    v_mul_f32 v12, 0x3b124925, v12
    v_mul_f32 v13, 0x3b124925, v13
    v_fma_f32 v13, -v12, v12, v13
    v_max_f32 v13, 0, v13
    v_add_f32 v16, 0x3727c5ac, v13
    v_rsq_f32 v16, v16
    s_nop 0
    v_mul_f32 v13, v13, v16
    v_mul_f32 v13, v13, v16
    v_add_f32 v13, 0x3727c5ac, v13
    v_rsq_f32 v13, v13
    s_nop 0
    v_mul_f32 v16, v16, v13
    v_mul_f32 v12, v12, v16
    v_sub_f32 v12, 0, v12
    v_mov_b32 v13, v12
    v_mov_b32 v17, v16
    v_pk_fma_f32 v[32:33], v[32:33], v[16:17], v[12:13]
    v_pk_fma_f32 v[34:35], v[34:35], v[16:17], v[12:13]
    v_pk_fma_f32 v[36:37], v[36:37], v[16:17], v[12:13]
    v_pk_fma_f32 v[38:39], v[38:39], v[16:17], v[12:13]
    v_pk_fma_f32 v[40:41], v[40:41], v[16:17], v[12:13]
    v_pk_fma_f32 v[42:43], v[42:43], v[16:17], v[12:13]
    v_pk_fma_f32 v[44:45], v[44:45], v[16:17], v[12:13]
    v_pk_fma_f32 v[46:47], v[46:47], v[16:17], v[12:13]
    v_pk_fma_f32 v[48:49], v[48:49], v[16:17], v[12:13]
    v_pk_fma_f32 v[50:51], v[50:51], v[16:17], v[12:13]
    v_pk_fma_f32 v[52:53], v[52:53], v[16:17], v[12:13]
    v_pk_fma_f32 v[54:55], v[54:55], v[16:17], v[12:13]
    v_pk_fma_f32 v[56:57], v[56:57], v[16:17], v[12:13]
    v_pk_fma_f32 v[58:59], v[58:59], v[16:17], v[12:13]
    v_pk_fma_f32 v[60:61], v[60:61], v[16:17], v[12:13]
    v_pk_fma_f32 v[62:63], v[62:63], v[16:17], v[12:13]
    v_cvt_pk_bf16_f32 v112, v32, v33
    v_cvt_pk_bf16_f32 v113, v34, v35
    v_cvt_pk_bf16_f32 v114, v36, v37
    v_cvt_pk_bf16_f32 v115, v38, v39
    v_cvt_pk_bf16_f32 v116, v40, v41
    v_cvt_pk_bf16_f32 v117, v42, v43
    v_cvt_pk_bf16_f32 v118, v44, v45
    v_cvt_pk_bf16_f32 v119, v46, v47
    v_cvt_pk_bf16_f32 v120, v48, v49
    v_cvt_pk_bf16_f32 v121, v50, v51
    v_cvt_pk_bf16_f32 v122, v52, v53
    v_cvt_pk_bf16_f32 v123, v54, v55
    v_cvt_pk_bf16_f32 v124, v56, v57
    v_cvt_pk_bf16_f32 v125, v58, v59
    v_cvt_pk_bf16_f32 v126, v60, v61
    v_cvt_pk_bf16_f32 v127, v62, v63
    v_and_b32 v14, 31, v2
    s_movk_i32 s42, 968
    v_mul_lo_u32 v14, v14, s42
    v_lshl_add_u32 v14, v10, 3, v14
    v_add_u32 v14, s33, v14
    ds_write_b64 v14, v[112:113] offset:0
    ds_write_b64 v14, v[114:115] offset:16
    ds_write_b64 v14, v[116:117] offset:32
    ds_write_b64 v14, v[118:119] offset:48
    ds_write_b64 v14, v[120:121] offset:64
    ds_write_b64 v14, v[122:123] offset:80
    ds_write_b64 v14, v[124:125] offset:96
    ds_write_b64 v14, v[126:127] offset:112
    s_waitcnt lgkmcnt(0)
    s_barrier
    v_lshrrev_b32 v15, 5, v2
    v_lshlrev_b32 v15, 3, v15
    v_bfe_u32 v16, v2, 2, 2
    v_add_u32 v15, v15, v16
    v_mul_lo_u32 v15, v15, s42
    v_bfe_u32 v16, v2, 4, 1
    v_lshl_add_u32 v15, v16, 5, v15
    v_and_b32 v16, 3, v2
    v_lshl_add_u32 v15, v16, 3, v15
    v_add_u32 v15, s33, v15
    ds_read_b64_tr_b16 v[64:65], v15 offset:0
    ds_read_b64_tr_b16 v[66:67], v15 offset:3872
    ds_read_b64_tr_b16 v[68:69], v15 offset:15488
    ds_read_b64_tr_b16 v[70:71], v15 offset:19360
    ds_read_b64_tr_b16 v[72:73], v15 offset:64
    ds_read_b64_tr_b16 v[74:75], v15 offset:3936
    ds_read_b64_tr_b16 v[76:77], v15 offset:15552
    ds_read_b64_tr_b16 v[78:79], v15 offset:19424
    s_waitcnt lgkmcnt(0)
    s_lshl_b32 s43, s30, 18
    s_lshl_b32 s44, s2, 11
    s_add_u32 s43, s43, s44
    s_add_u32 s43, s43, 6291456
    s_add_u32 s45, s43, 131072
    buffer_store_dwordx4 v[64:67], v1, s[24:27], s43 offen offset:0
    buffer_store_dwordx4 v[68:71], v1, s[24:27], s43 offen offset:1024
    buffer_store_dwordx4 v[72:75], v1, s[24:27], s45 offen offset:0
    buffer_store_dwordx4 v[76:79], v1, s[24:27], s45 offen offset:1024
    s_endpgm
K3_END:
    s_endpgm
.section .rodata,"a"
.p2align 6
.amdhsa_kernel k3_kernel
  .amdhsa_next_free_vgpr 128
  .amdhsa_next_free_sgpr 102
  .amdhsa_accum_offset 128
  .amdhsa_group_segment_fixed_size 0
  .amdhsa_kernarg_size 104
  .amdhsa_user_sgpr_count 2
  .amdhsa_user_sgpr_kernarg_segment_ptr 1
  .amdhsa_system_sgpr_workgroup_id_x 1
.end_amdhsa_kernel
.text
.globl k4_kernel
.p2align 8
.type k4_kernel,@function
k4_kernel:
    s_cmp_ge_u32 s2, 200
    s_cbranch_scc1 K4_END
    s_load_dwordx2 s[6:7], s[0:1], 48
    s_load_dwordx2 s[8:9], s[0:1], 56
    s_load_dwordx2 s[10:11], s[0:1], 80
    s_load_dwordx2 s[12:13], s[0:1], 96
    v_lshrrev_b32 v1, 6, v0
    v_and_b32 v2, 63, v0
    v_readfirstlane_b32 s30, v1
    s_and_b32 s33, s2, 7
    s_mul_i32 s33, s33, 25
    s_lshr_b32 s34, s2, 3
    s_add_u32 s34, s34, s33
    s_cmp_ge_u32 s34, 196
    s_cbranch_scc1 K4_END
    s_mov_b32 s33, 0x24924925
    s_mul_hi_u32 s29, s34, s33
    s_mul_i32 s33, s29, 7
    s_sub_u32 s28, s34, s33
    s_movk_i32 s31, 3584
    v_lshlrev_b32 v1, 4, v2
    v_lshrrev_b32 v4, 3, v2
    v_mul_lo_u32 v3, v4, s31
    v_bfe_u32 v4, v2, 4, 1
    v_lshlrev_b32 v4, 2, v4
    v_xor_b32 v4, v4, v2
    v_and_b32 v4, 7, v4
    v_lshl_add_u32 v3, v4, 4, v3
    v_lshrrev_b32 v7, 5, v2
    v_lshlrev_b32 v7, 3, v7
    v_bfe_u32 v8, v2, 2, 2
    v_add_u32 v7, v7, v8
    v_lshlrev_b32 v5, 7, v7
    v_bfe_u32 v8, v2, 4, 1
    v_lshl_add_u32 v5, v8, 5, v5
    v_and_b32 v8, 3, v2
    v_lshl_add_u32 v5, v8, 3, v5
    v_bfe_u32 v8, v2, 3, 1
    v_lshlrev_b32 v8, 6, v8
    v_xor_b32 v5, v5, v8
    v_xor_b32 v6, 64, v5
    s_lshl_b32 s32, s30, 15
    v_add_u32 v5, s32, v5
    v_add_u32 v6, s32, v6
    s_lshl_b32 s33, s29, 7
    v_add_u32 v3, s33, v3
    s_waitcnt lgkmcnt(0)
    s_mov_b32 s20, s6
    s_and_b32 s21, s7, 0xffff
    s_mov_b32 s22, 7340032
    s_mov_b32 s23, 0x00020000
    s_mov_b32 s24, s12
    s_and_b32 s25, s13, 0xffff
    s_mov_b32 s26, 67108864
    s_mov_b32 s27, 0x00020000
    s_mul_i32 s34, s30, 1835008
    s_mul_i32 s35, s28, 262144
    s_mul_i32 s36, s30, 32768
    s_add_u32 s35, s35, s36
    s_add_u32 s35, s35, 6291456
    s_add_u32 s36, s35, 131072
    s_lshr_b32 s41, s30, 1
    s_and_b32 s42, s30, 1
    v_lshrrev_b32 v10, 5, v2
    s_mov_b32 s16, s8
    s_and_b32 s17, s9, 0xffff
    s_mov_b32 s18, 3584
    s_mov_b32 s19, 0x00020000
    s_lshl_b32 s43, s29, 6
    s_lshl_b32 s44, s41, 5
    s_add_u32 s43, s43, s44
    s_lshl_b32 s44, s43, 1
    v_lshlrev_b32 v11, 3, v10
    buffer_load_dwordx2 v[16:17], v11, s[16:19], s44 offen offset:0
    buffer_load_dwordx2 v[18:19], v11, s[16:19], s44 offen offset:16
    buffer_load_dwordx2 v[20:21], v11, s[16:19], s44 offen offset:32
    buffer_load_dwordx2 v[22:23], v11, s[16:19], s44 offen offset:48
    s_add_u32 s40, s32, 0
    s_mov_b32 m0, s40
    s_add_u32 s41, s34, 0
    buffer_load_dwordx4 v3, s[20:23], s41 offen lds
    s_add_u32 s40, s32, 1024
    s_mov_b32 m0, s40
    s_add_u32 s41, s34, 28672
    buffer_load_dwordx4 v3, s[20:23], s41 offen lds
    s_add_u32 s40, s32, 2048
    s_mov_b32 m0, s40
    s_add_u32 s41, s34, 57344
    buffer_load_dwordx4 v3, s[20:23], s41 offen lds
    s_add_u32 s40, s32, 3072
    s_mov_b32 m0, s40
    s_add_u32 s41, s34, 86016
    buffer_load_dwordx4 v3, s[20:23], s41 offen lds
    s_add_u32 s40, s32, 4096
    s_mov_b32 m0, s40
    s_add_u32 s41, s34, 114688
    buffer_load_dwordx4 v3, s[20:23], s41 offen lds
    s_add_u32 s40, s32, 5120
    s_mov_b32 m0, s40
    s_add_u32 s41, s34, 143360
    buffer_load_dwordx4 v3, s[20:23], s41 offen lds
    s_add_u32 s40, s32, 6144
    s_mov_b32 m0, s40
    s_add_u32 s41, s34, 172032
    buffer_load_dwordx4 v3, s[20:23], s41 offen lds
    s_add_u32 s40, s32, 7168
    s_mov_b32 m0, s40
    s_add_u32 s41, s34, 200704
    buffer_load_dwordx4 v3, s[20:23], s41 offen lds
    s_add_u32 s40, s32, 8192
    s_mov_b32 m0, s40
    s_add_u32 s41, s34, 229376
    buffer_load_dwordx4 v3, s[20:23], s41 offen lds
    s_add_u32 s40, s32, 9216
    s_mov_b32 m0, s40
    s_add_u32 s41, s34, 258048
    buffer_load_dwordx4 v3, s[20:23], s41 offen lds
    s_add_u32 s42, s35, 0
    buffer_load_dwordx4 v[128:131], v1, s[24:27], s42 offen
    s_add_u32 s42, s36, 0
    buffer_load_dwordx4 v[132:135], v1, s[24:27], s42 offen
    s_add_u32 s40, s32, 10240
    s_mov_b32 m0, s40
    s_add_u32 s41, s34, 286720
    buffer_load_dwordx4 v3, s[20:23], s41 offen lds
    s_add_u32 s40, s32, 11264
    s_mov_b32 m0, s40
    s_add_u32 s41, s34, 315392
    buffer_load_dwordx4 v3, s[20:23], s41 offen lds
    s_add_u32 s42, s35, 1024
    buffer_load_dwordx4 v[136:139], v1, s[24:27], s42 offen
    s_add_u32 s42, s36, 1024
    buffer_load_dwordx4 v[140:143], v1, s[24:27], s42 offen
    s_add_u32 s40, s32, 12288
    s_mov_b32 m0, s40
    s_add_u32 s41, s34, 344064
    buffer_load_dwordx4 v3, s[20:23], s41 offen lds
    s_add_u32 s40, s32, 13312
    s_mov_b32 m0, s40
    s_add_u32 s41, s34, 372736
    buffer_load_dwordx4 v3, s[20:23], s41 offen lds
    s_add_u32 s42, s35, 2048
    buffer_load_dwordx4 v[144:147], v1, s[24:27], s42 offen
    s_add_u32 s42, s36, 2048
    buffer_load_dwordx4 v[148:151], v1, s[24:27], s42 offen
    s_add_u32 s40, s32, 14336
    s_mov_b32 m0, s40
    s_add_u32 s41, s34, 401408
    buffer_load_dwordx4 v3, s[20:23], s41 offen lds
    s_add_u32 s40, s32, 15360
    s_mov_b32 m0, s40
    s_add_u32 s41, s34, 430080
    buffer_load_dwordx4 v3, s[20:23], s41 offen lds
    s_add_u32 s42, s35, 3072
    buffer_load_dwordx4 v[152:155], v1, s[24:27], s42 offen
    s_add_u32 s42, s36, 3072
    buffer_load_dwordx4 v[156:159], v1, s[24:27], s42 offen
    s_add_u32 s40, s32, 16384
    s_mov_b32 m0, s40
    s_add_u32 s41, s34, 458752
    buffer_load_dwordx4 v3, s[20:23], s41 offen lds
    s_add_u32 s40, s32, 17408
    s_mov_b32 m0, s40
    s_add_u32 s41, s34, 487424
    buffer_load_dwordx4 v3, s[20:23], s41 offen lds
    s_add_u32 s42, s35, 4096
    buffer_load_dwordx4 v[160:163], v1, s[24:27], s42 offen
    s_add_u32 s42, s36, 4096
    buffer_load_dwordx4 v[164:167], v1, s[24:27], s42 offen
    s_add_u32 s40, s32, 18432
    s_mov_b32 m0, s40
    s_add_u32 s41, s34, 516096
    buffer_load_dwordx4 v3, s[20:23], s41 offen lds
    s_add_u32 s40, s32, 19456
    s_mov_b32 m0, s40
    s_add_u32 s41, s34, 544768
    buffer_load_dwordx4 v3, s[20:23], s41 offen lds
    s_add_u32 s42, s35, 5120
    buffer_load_dwordx4 v[168:171], v1, s[24:27], s42 offen
    s_add_u32 s42, s36, 5120
    buffer_load_dwordx4 v[172:175], v1, s[24:27], s42 offen
    s_add_u32 s40, s32, 20480
    s_mov_b32 m0, s40
    s_add_u32 s41, s34, 573440
    buffer_load_dwordx4 v3, s[20:23], s41 offen lds
    s_add_u32 s40, s32, 21504
    s_mov_b32 m0, s40
    s_add_u32 s41, s34, 602112
    buffer_load_dwordx4 v3, s[20:23], s41 offen lds
    s_add_u32 s42, s35, 6144
    buffer_load_dwordx4 v[176:179], v1, s[24:27], s42 offen
    s_add_u32 s42, s36, 6144
    buffer_load_dwordx4 v[180:183], v1, s[24:27], s42 offen
    s_add_u32 s40, s32, 22528
    s_mov_b32 m0, s40
    s_add_u32 s41, s34, 630784
    buffer_load_dwordx4 v3, s[20:23], s41 offen lds
    s_add_u32 s40, s32, 23552
    s_mov_b32 m0, s40
    s_add_u32 s41, s34, 659456
    buffer_load_dwordx4 v3, s[20:23], s41 offen lds
    s_add_u32 s42, s35, 7168
    buffer_load_dwordx4 v[184:187], v1, s[24:27], s42 offen
    s_add_u32 s42, s36, 7168
    buffer_load_dwordx4 v[188:191], v1, s[24:27], s42 offen
    s_waitcnt vmcnt(38)
    ds_read_b64_tr_b16 v[192:193], v5 offset:0
    ds_read_b64_tr_b16 v[194:195], v5 offset:512
    ds_read_b64_tr_b16 v[196:197], v6 offset:0
    ds_read_b64_tr_b16 v[198:199], v6 offset:512
    s_add_u32 s40, s32, 24576
    s_mov_b32 m0, s40
    s_add_u32 s41, s34, 688128
    buffer_load_dwordx4 v3, s[20:23], s41 offen lds
    s_add_u32 s40, s32, 25600
    s_mov_b32 m0, s40
    s_add_u32 s41, s34, 716800
    buffer_load_dwordx4 v3, s[20:23], s41 offen lds
    s_waitcnt vmcnt(30)
    s_waitcnt lgkmcnt(0)
    ds_read_b64_tr_b16 v[200:201], v5 offset:2048
    ds_read_b64_tr_b16 v[202:203], v5 offset:2560
    ds_read_b64_tr_b16 v[204:205], v6 offset:2048
    ds_read_b64_tr_b16 v[206:207], v6 offset:2560
    v_mfma_f32_32x32x16_bf16 v[64:79], v[192:195], v[128:131], 0
    v_mfma_f32_32x32x16_bf16 v[80:95], v[192:195], v[132:135], 0
    v_mfma_f32_32x32x16_bf16 v[96:111], v[196:199], v[128:131], 0
    v_mfma_f32_32x32x16_bf16 v[112:127], v[196:199], v[132:135], 0
    s_add_u32 s42, s35, 8192
    buffer_load_dwordx4 v[128:131], v1, s[24:27], s42 offen
    s_add_u32 s42, s36, 8192
    buffer_load_dwordx4 v[132:135], v1, s[24:27], s42 offen
    s_add_u32 s40, s32, 26624
    s_mov_b32 m0, s40
    s_add_u32 s41, s34, 745472
    buffer_load_dwordx4 v3, s[20:23], s41 offen lds
    s_add_u32 s40, s32, 27648
    s_mov_b32 m0, s40
    s_add_u32 s41, s34, 774144
    buffer_load_dwordx4 v3, s[20:23], s41 offen lds
    s_waitcnt vmcnt(30)
    s_waitcnt lgkmcnt(0)
    ds_read_b64_tr_b16 v[192:193], v5 offset:4096
    ds_read_b64_tr_b16 v[194:195], v5 offset:4608
    ds_read_b64_tr_b16 v[196:197], v6 offset:4096
    ds_read_b64_tr_b16 v[198:199], v6 offset:4608
    v_mfma_f32_32x32x16_bf16 v[64:79], v[200:203], v[136:139], v[64:79]
    v_mfma_f32_32x32x16_bf16 v[80:95], v[200:203], v[140:143], v[80:95]
    v_mfma_f32_32x32x16_bf16 v[96:111], v[204:207], v[136:139], v[96:111]
    v_mfma_f32_32x32x16_bf16 v[112:127], v[204:207], v[140:143], v[112:127]
    s_add_u32 s42, s35, 9216
    buffer_load_dwordx4 v[136:139], v1, s[24:27], s42 offen
    s_add_u32 s42, s36, 9216
    buffer_load_dwordx4 v[140:143], v1, s[24:27], s42 offen
    s_add_u32 s40, s32, 28672
    s_mov_b32 m0, s40
    s_add_u32 s41, s34, 802816
    buffer_load_dwordx4 v3, s[20:23], s41 offen lds
    s_add_u32 s40, s32, 29696
    s_mov_b32 m0, s40
    s_add_u32 s41, s34, 831488
    buffer_load_dwordx4 v3, s[20:23], s41 offen lds
    s_waitcnt vmcnt(30)
    s_waitcnt lgkmcnt(0)
    ds_read_b64_tr_b16 v[200:201], v5 offset:6144
    ds_read_b64_tr_b16 v[202:203], v5 offset:6656
    ds_read_b64_tr_b16 v[204:205], v6 offset:6144
    ds_read_b64_tr_b16 v[206:207], v6 offset:6656
    v_mfma_f32_32x32x16_bf16 v[64:79], v[192:195], v[144:147], v[64:79]
    v_mfma_f32_32x32x16_bf16 v[80:95], v[192:195], v[148:151], v[80:95]
    v_mfma_f32_32x32x16_bf16 v[96:111], v[196:199], v[144:147], v[96:111]
    v_mfma_f32_32x32x16_bf16 v[112:127], v[196:199], v[148:151], v[112:127]
    s_add_u32 s42, s35, 10240
    buffer_load_dwordx4 v[144:147], v1, s[24:27], s42 offen
    s_add_u32 s42, s36, 10240
    buffer_load_dwordx4 v[148:151], v1, s[24:27], s42 offen
    s_add_u32 s40, s32, 30720
    s_mov_b32 m0, s40
    s_add_u32 s41, s34, 860160
    buffer_load_dwordx4 v3, s[20:23], s41 offen lds
    s_add_u32 s40, s32, 31744
    s_mov_b32 m0, s40
    s_add_u32 s41, s34, 888832
    buffer_load_dwordx4 v3, s[20:23], s41 offen lds
    s_waitcnt vmcnt(30)
    s_waitcnt lgkmcnt(0)
    ds_read_b64_tr_b16 v[192:193], v5 offset:8192
    ds_read_b64_tr_b16 v[194:195], v5 offset:8704
    ds_read_b64_tr_b16 v[196:197], v6 offset:8192
    ds_read_b64_tr_b16 v[198:199], v6 offset:8704
    v_mfma_f32_32x32x16_bf16 v[64:79], v[200:203], v[152:155], v[64:79]
    v_mfma_f32_32x32x16_bf16 v[80:95], v[200:203], v[156:159], v[80:95]
    v_mfma_f32_32x32x16_bf16 v[96:111], v[204:207], v[152:155], v[96:111]
    v_mfma_f32_32x32x16_bf16 v[112:127], v[204:207], v[156:159], v[112:127]
    s_add_u32 s42, s35, 11264
    buffer_load_dwordx4 v[152:155], v1, s[24:27], s42 offen
    s_add_u32 s42, s36, 11264
    buffer_load_dwordx4 v[156:159], v1, s[24:27], s42 offen
    s_add_u32 s40, s32, 0
    s_mov_b32 m0, s40
    s_add_u32 s41, s34, 917504
    buffer_load_dwordx4 v3, s[20:23], s41 offen lds
    s_add_u32 s40, s32, 1024
    s_mov_b32 m0, s40
    s_add_u32 s41, s34, 946176
    buffer_load_dwordx4 v3, s[20:23], s41 offen lds
    s_waitcnt vmcnt(30)
    s_waitcnt lgkmcnt(0)
    ds_read_b64_tr_b16 v[200:201], v5 offset:10240
    ds_read_b64_tr_b16 v[202:203], v5 offset:10752
    ds_read_b64_tr_b16 v[204:205], v6 offset:10240
    ds_read_b64_tr_b16 v[206:207], v6 offset:10752
    v_mfma_f32_32x32x16_bf16 v[64:79], v[192:195], v[160:163], v[64:79]
    v_mfma_f32_32x32x16_bf16 v[80:95], v[192:195], v[164:167], v[80:95]
    v_mfma_f32_32x32x16_bf16 v[96:111], v[196:199], v[160:163], v[96:111]
    v_mfma_f32_32x32x16_bf16 v[112:127], v[196:199], v[164:167], v[112:127]
    s_add_u32 s42, s35, 12288
    buffer_load_dwordx4 v[160:163], v1, s[24:27], s42 offen
    s_add_u32 s42, s36, 12288
    buffer_load_dwordx4 v[164:167], v1, s[24:27], s42 offen
    s_add_u32 s40, s32, 2048
    s_mov_b32 m0, s40
    s_add_u32 s41, s34, 974848
    buffer_load_dwordx4 v3, s[20:23], s41 offen lds
    s_add_u32 s40, s32, 3072
    s_mov_b32 m0, s40
    s_add_u32 s41, s34, 1003520
    buffer_load_dwordx4 v3, s[20:23], s41 offen lds
    s_waitcnt vmcnt(30)
    s_waitcnt lgkmcnt(0)
    ds_read_b64_tr_b16 v[192:193], v5 offset:12288
    ds_read_b64_tr_b16 v[194:195], v5 offset:12800
    ds_read_b64_tr_b16 v[196:197], v6 offset:12288
    ds_read_b64_tr_b16 v[198:199], v6 offset:12800
    v_mfma_f32_32x32x16_bf16 v[64:79], v[200:203], v[168:171], v[64:79]
    v_mfma_f32_32x32x16_bf16 v[80:95], v[200:203], v[172:175], v[80:95]
    v_mfma_f32_32x32x16_bf16 v[96:111], v[204:207], v[168:171], v[96:111]
    v_mfma_f32_32x32x16_bf16 v[112:127], v[204:207], v[172:175], v[112:127]
    s_add_u32 s42, s35, 13312
    buffer_load_dwordx4 v[168:171], v1, s[24:27], s42 offen
    s_add_u32 s42, s36, 13312
    buffer_load_dwordx4 v[172:175], v1, s[24:27], s42 offen
    s_add_u32 s40, s32, 4096
    s_mov_b32 m0, s40
    s_add_u32 s41, s34, 1032192
    buffer_load_dwordx4 v3, s[20:23], s41 offen lds
    s_add_u32 s40, s32, 5120
    s_mov_b32 m0, s40
    s_add_u32 s41, s34, 1060864
    buffer_load_dwordx4 v3, s[20:23], s41 offen lds
    s_waitcnt vmcnt(30)
    s_waitcnt lgkmcnt(0)
    ds_read_b64_tr_b16 v[200:201], v5 offset:14336
    ds_read_b64_tr_b16 v[202:203], v5 offset:14848
    ds_read_b64_tr_b16 v[204:205], v6 offset:14336
    ds_read_b64_tr_b16 v[206:207], v6 offset:14848
    v_mfma_f32_32x32x16_bf16 v[64:79], v[192:195], v[176:179], v[64:79]
    v_mfma_f32_32x32x16_bf16 v[80:95], v[192:195], v[180:183], v[80:95]
    v_mfma_f32_32x32x16_bf16 v[96:111], v[196:199], v[176:179], v[96:111]
    v_mfma_f32_32x32x16_bf16 v[112:127], v[196:199], v[180:183], v[112:127]
    s_add_u32 s42, s35, 14336
    buffer_load_dwordx4 v[176:179], v1, s[24:27], s42 offen
    s_add_u32 s42, s36, 14336
    buffer_load_dwordx4 v[180:183], v1, s[24:27], s42 offen
    s_add_u32 s40, s32, 6144
    s_mov_b32 m0, s40
    s_add_u32 s41, s34, 1089536
    buffer_load_dwordx4 v3, s[20:23], s41 offen lds
    s_add_u32 s40, s32, 7168
    s_mov_b32 m0, s40
    s_add_u32 s41, s34, 1118208
    buffer_load_dwordx4 v3, s[20:23], s41 offen lds
    s_waitcnt vmcnt(30)
    s_waitcnt lgkmcnt(0)
    ds_read_b64_tr_b16 v[192:193], v5 offset:16384
    ds_read_b64_tr_b16 v[194:195], v5 offset:16896
    ds_read_b64_tr_b16 v[196:197], v6 offset:16384
    ds_read_b64_tr_b16 v[198:199], v6 offset:16896
    v_mfma_f32_32x32x16_bf16 v[64:79], v[200:203], v[184:187], v[64:79]
    v_mfma_f32_32x32x16_bf16 v[80:95], v[200:203], v[188:191], v[80:95]
    v_mfma_f32_32x32x16_bf16 v[96:111], v[204:207], v[184:187], v[96:111]
    v_mfma_f32_32x32x16_bf16 v[112:127], v[204:207], v[188:191], v[112:127]
    s_add_u32 s42, s35, 15360
    buffer_load_dwordx4 v[184:187], v1, s[24:27], s42 offen
    s_add_u32 s42, s36, 15360
    buffer_load_dwordx4 v[188:191], v1, s[24:27], s42 offen
    s_add_u32 s40, s32, 8192
    s_mov_b32 m0, s40
    s_add_u32 s41, s34, 1146880
    buffer_load_dwordx4 v3, s[20:23], s41 offen lds
    s_add_u32 s40, s32, 9216
    s_mov_b32 m0, s40
    s_add_u32 s41, s34, 1175552
    buffer_load_dwordx4 v3, s[20:23], s41 offen lds
    s_waitcnt vmcnt(30)
    s_waitcnt lgkmcnt(0)
    ds_read_b64_tr_b16 v[200:201], v5 offset:18432
    ds_read_b64_tr_b16 v[202:203], v5 offset:18944
    ds_read_b64_tr_b16 v[204:205], v6 offset:18432
    ds_read_b64_tr_b16 v[206:207], v6 offset:18944
    v_mfma_f32_32x32x16_bf16 v[64:79], v[192:195], v[128:131], v[64:79]
    v_mfma_f32_32x32x16_bf16 v[80:95], v[192:195], v[132:135], v[80:95]
    v_mfma_f32_32x32x16_bf16 v[96:111], v[196:199], v[128:131], v[96:111]
    v_mfma_f32_32x32x16_bf16 v[112:127], v[196:199], v[132:135], v[112:127]
    s_add_u32 s42, s35, 16384
    buffer_load_dwordx4 v[128:131], v1, s[24:27], s42 offen
    s_add_u32 s42, s36, 16384
    buffer_load_dwordx4 v[132:135], v1, s[24:27], s42 offen
    s_add_u32 s40, s32, 10240
    s_mov_b32 m0, s40
    s_add_u32 s41, s34, 1204224
    buffer_load_dwordx4 v3, s[20:23], s41 offen lds
    s_add_u32 s40, s32, 11264
    s_mov_b32 m0, s40
    s_add_u32 s41, s34, 1232896
    buffer_load_dwordx4 v3, s[20:23], s41 offen lds
    s_waitcnt vmcnt(30)
    s_waitcnt lgkmcnt(0)
    ds_read_b64_tr_b16 v[192:193], v5 offset:20480
    ds_read_b64_tr_b16 v[194:195], v5 offset:20992
    ds_read_b64_tr_b16 v[196:197], v6 offset:20480
    ds_read_b64_tr_b16 v[198:199], v6 offset:20992
    v_mfma_f32_32x32x16_bf16 v[64:79], v[200:203], v[136:139], v[64:79]
    v_mfma_f32_32x32x16_bf16 v[80:95], v[200:203], v[140:143], v[80:95]
    v_mfma_f32_32x32x16_bf16 v[96:111], v[204:207], v[136:139], v[96:111]
    v_mfma_f32_32x32x16_bf16 v[112:127], v[204:207], v[140:143], v[112:127]
    s_add_u32 s42, s35, 17408
    buffer_load_dwordx4 v[136:139], v1, s[24:27], s42 offen
    s_add_u32 s42, s36, 17408
    buffer_load_dwordx4 v[140:143], v1, s[24:27], s42 offen
    s_add_u32 s40, s32, 12288
    s_mov_b32 m0, s40
    s_add_u32 s41, s34, 1261568
    buffer_load_dwordx4 v3, s[20:23], s41 offen lds
    s_add_u32 s40, s32, 13312
    s_mov_b32 m0, s40
    s_add_u32 s41, s34, 1290240
    buffer_load_dwordx4 v3, s[20:23], s41 offen lds
    s_waitcnt vmcnt(30)
    s_waitcnt lgkmcnt(0)
    ds_read_b64_tr_b16 v[200:201], v5 offset:22528
    ds_read_b64_tr_b16 v[202:203], v5 offset:23040
    ds_read_b64_tr_b16 v[204:205], v6 offset:22528
    ds_read_b64_tr_b16 v[206:207], v6 offset:23040
    v_mfma_f32_32x32x16_bf16 v[64:79], v[192:195], v[144:147], v[64:79]
    v_mfma_f32_32x32x16_bf16 v[80:95], v[192:195], v[148:151], v[80:95]
    v_mfma_f32_32x32x16_bf16 v[96:111], v[196:199], v[144:147], v[96:111]
    v_mfma_f32_32x32x16_bf16 v[112:127], v[196:199], v[148:151], v[112:127]
    s_add_u32 s42, s35, 18432
    buffer_load_dwordx4 v[144:147], v1, s[24:27], s42 offen
    s_add_u32 s42, s36, 18432
    buffer_load_dwordx4 v[148:151], v1, s[24:27], s42 offen
    s_add_u32 s40, s32, 14336
    s_mov_b32 m0, s40
    s_add_u32 s41, s34, 1318912
    buffer_load_dwordx4 v3, s[20:23], s41 offen lds
    s_add_u32 s40, s32, 15360
    s_mov_b32 m0, s40
    s_add_u32 s41, s34, 1347584
    buffer_load_dwordx4 v3, s[20:23], s41 offen lds
    s_waitcnt vmcnt(30)
    s_waitcnt lgkmcnt(0)
    ds_read_b64_tr_b16 v[192:193], v5 offset:24576
    ds_read_b64_tr_b16 v[194:195], v5 offset:25088
    ds_read_b64_tr_b16 v[196:197], v6 offset:24576
    ds_read_b64_tr_b16 v[198:199], v6 offset:25088
    v_mfma_f32_32x32x16_bf16 v[64:79], v[200:203], v[152:155], v[64:79]
    v_mfma_f32_32x32x16_bf16 v[80:95], v[200:203], v[156:159], v[80:95]
    v_mfma_f32_32x32x16_bf16 v[96:111], v[204:207], v[152:155], v[96:111]
    v_mfma_f32_32x32x16_bf16 v[112:127], v[204:207], v[156:159], v[112:127]
    s_add_u32 s42, s35, 19456
    buffer_load_dwordx4 v[152:155], v1, s[24:27], s42 offen
    s_add_u32 s42, s36, 19456
    buffer_load_dwordx4 v[156:159], v1, s[24:27], s42 offen
    s_add_u32 s40, s32, 16384
    s_mov_b32 m0, s40
    s_add_u32 s41, s34, 1376256
    buffer_load_dwordx4 v3, s[20:23], s41 offen lds
    s_add_u32 s40, s32, 17408
    s_mov_b32 m0, s40
    s_add_u32 s41, s34, 1404928
    buffer_load_dwordx4 v3, s[20:23], s41 offen lds
    s_waitcnt vmcnt(30)
    s_waitcnt lgkmcnt(0)
    ds_read_b64_tr_b16 v[200:201], v5 offset:26624
    ds_read_b64_tr_b16 v[202:203], v5 offset:27136
    ds_read_b64_tr_b16 v[204:205], v6 offset:26624
    ds_read_b64_tr_b16 v[206:207], v6 offset:27136
    v_mfma_f32_32x32x16_bf16 v[64:79], v[192:195], v[160:163], v[64:79]
    v_mfma_f32_32x32x16_bf16 v[80:95], v[192:195], v[164:167], v[80:95]
    v_mfma_f32_32x32x16_bf16 v[96:111], v[196:199], v[160:163], v[96:111]
    v_mfma_f32_32x32x16_bf16 v[112:127], v[196:199], v[164:167], v[112:127]
    s_add_u32 s42, s35, 20480
    buffer_load_dwordx4 v[160:163], v1, s[24:27], s42 offen
    s_add_u32 s42, s36, 20480
    buffer_load_dwordx4 v[164:167], v1, s[24:27], s42 offen
    s_add_u32 s40, s32, 18432
    s_mov_b32 m0, s40
    s_add_u32 s41, s34, 1433600
    buffer_load_dwordx4 v3, s[20:23], s41 offen lds
    s_add_u32 s40, s32, 19456
    s_mov_b32 m0, s40
    s_add_u32 s41, s34, 1462272
    buffer_load_dwordx4 v3, s[20:23], s41 offen lds
    s_waitcnt vmcnt(30)
    s_waitcnt lgkmcnt(0)
    ds_read_b64_tr_b16 v[192:193], v5 offset:28672
    ds_read_b64_tr_b16 v[194:195], v5 offset:29184
    ds_read_b64_tr_b16 v[196:197], v6 offset:28672
    ds_read_b64_tr_b16 v[198:199], v6 offset:29184
    v_mfma_f32_32x32x16_bf16 v[64:79], v[200:203], v[168:171], v[64:79]
    v_mfma_f32_32x32x16_bf16 v[80:95], v[200:203], v[172:175], v[80:95]
    v_mfma_f32_32x32x16_bf16 v[96:111], v[204:207], v[168:171], v[96:111]
    v_mfma_f32_32x32x16_bf16 v[112:127], v[204:207], v[172:175], v[112:127]
    s_add_u32 s42, s35, 21504
    buffer_load_dwordx4 v[168:171], v1, s[24:27], s42 offen
    s_add_u32 s42, s36, 21504
    buffer_load_dwordx4 v[172:175], v1, s[24:27], s42 offen
    s_add_u32 s40, s32, 20480
    s_mov_b32 m0, s40
    s_add_u32 s41, s34, 1490944
    buffer_load_dwordx4 v3, s[20:23], s41 offen lds
    s_add_u32 s40, s32, 21504
    s_mov_b32 m0, s40
    s_add_u32 s41, s34, 1519616
    buffer_load_dwordx4 v3, s[20:23], s41 offen lds
    s_waitcnt vmcnt(30)
    s_waitcnt lgkmcnt(0)
    ds_read_b64_tr_b16 v[200:201], v5 offset:30720
    ds_read_b64_tr_b16 v[202:203], v5 offset:31232
    ds_read_b64_tr_b16 v[204:205], v6 offset:30720
    ds_read_b64_tr_b16 v[206:207], v6 offset:31232
    v_mfma_f32_32x32x16_bf16 v[64:79], v[192:195], v[176:179], v[64:79]
    v_mfma_f32_32x32x16_bf16 v[80:95], v[192:195], v[180:183], v[80:95]
    v_mfma_f32_32x32x16_bf16 v[96:111], v[196:199], v[176:179], v[96:111]
    v_mfma_f32_32x32x16_bf16 v[112:127], v[196:199], v[180:183], v[112:127]
    s_add_u32 s42, s35, 22528
    buffer_load_dwordx4 v[176:179], v1, s[24:27], s42 offen
    s_add_u32 s42, s36, 22528
    buffer_load_dwordx4 v[180:183], v1, s[24:27], s42 offen
    s_add_u32 s40, s32, 22528
    s_mov_b32 m0, s40
    s_add_u32 s41, s34, 1548288
    buffer_load_dwordx4 v3, s[20:23], s41 offen lds
    s_add_u32 s40, s32, 23552
    s_mov_b32 m0, s40
    s_add_u32 s41, s34, 1576960
    buffer_load_dwordx4 v3, s[20:23], s41 offen lds
    s_waitcnt vmcnt(30)
    s_waitcnt lgkmcnt(0)
    ds_read_b64_tr_b16 v[192:193], v5 offset:0
    ds_read_b64_tr_b16 v[194:195], v5 offset:512
    ds_read_b64_tr_b16 v[196:197], v6 offset:0
    ds_read_b64_tr_b16 v[198:199], v6 offset:512
    v_mfma_f32_32x32x16_bf16 v[64:79], v[200:203], v[184:187], v[64:79]
    v_mfma_f32_32x32x16_bf16 v[80:95], v[200:203], v[188:191], v[80:95]
    v_mfma_f32_32x32x16_bf16 v[96:111], v[204:207], v[184:187], v[96:111]
    v_mfma_f32_32x32x16_bf16 v[112:127], v[204:207], v[188:191], v[112:127]
    s_add_u32 s42, s35, 23552
    buffer_load_dwordx4 v[184:187], v1, s[24:27], s42 offen
    s_add_u32 s42, s36, 23552
    buffer_load_dwordx4 v[188:191], v1, s[24:27], s42 offen
    s_add_u32 s40, s32, 24576
    s_mov_b32 m0, s40
    s_add_u32 s41, s34, 1605632
    buffer_load_dwordx4 v3, s[20:23], s41 offen lds
    s_add_u32 s40, s32, 25600
    s_mov_b32 m0, s40
    s_add_u32 s41, s34, 1634304
    buffer_load_dwordx4 v3, s[20:23], s41 offen lds
    s_waitcnt vmcnt(30)
    s_waitcnt lgkmcnt(0)
    ds_read_b64_tr_b16 v[200:201], v5 offset:2048
    ds_read_b64_tr_b16 v[202:203], v5 offset:2560
    ds_read_b64_tr_b16 v[204:205], v6 offset:2048
    ds_read_b64_tr_b16 v[206:207], v6 offset:2560
    v_mfma_f32_32x32x16_bf16 v[64:79], v[192:195], v[128:131], v[64:79]
    v_mfma_f32_32x32x16_bf16 v[80:95], v[192:195], v[132:135], v[80:95]
    v_mfma_f32_32x32x16_bf16 v[96:111], v[196:199], v[128:131], v[96:111]
    v_mfma_f32_32x32x16_bf16 v[112:127], v[196:199], v[132:135], v[112:127]
    s_add_u32 s42, s35, 24576
    buffer_load_dwordx4 v[128:131], v1, s[24:27], s42 offen
    s_add_u32 s42, s36, 24576
    buffer_load_dwordx4 v[132:135], v1, s[24:27], s42 offen
    s_add_u32 s40, s32, 26624
    s_mov_b32 m0, s40
    s_add_u32 s41, s34, 1662976
    buffer_load_dwordx4 v3, s[20:23], s41 offen lds
    s_add_u32 s40, s32, 27648
    s_mov_b32 m0, s40
    s_add_u32 s41, s34, 1691648
    buffer_load_dwordx4 v3, s[20:23], s41 offen lds
    s_waitcnt vmcnt(30)
    s_waitcnt lgkmcnt(0)
    ds_read_b64_tr_b16 v[192:193], v5 offset:4096
    ds_read_b64_tr_b16 v[194:195], v5 offset:4608
    ds_read_b64_tr_b16 v[196:197], v6 offset:4096
    ds_read_b64_tr_b16 v[198:199], v6 offset:4608
    v_mfma_f32_32x32x16_bf16 v[64:79], v[200:203], v[136:139], v[64:79]
    v_mfma_f32_32x32x16_bf16 v[80:95], v[200:203], v[140:143], v[80:95]
    v_mfma_f32_32x32x16_bf16 v[96:111], v[204:207], v[136:139], v[96:111]
    v_mfma_f32_32x32x16_bf16 v[112:127], v[204:207], v[140:143], v[112:127]
    s_add_u32 s42, s35, 25600
    buffer_load_dwordx4 v[136:139], v1, s[24:27], s42 offen
    s_add_u32 s42, s36, 25600
    buffer_load_dwordx4 v[140:143], v1, s[24:27], s42 offen
    s_add_u32 s40, s32, 28672
    s_mov_b32 m0, s40
    s_add_u32 s41, s34, 1720320
    buffer_load_dwordx4 v3, s[20:23], s41 offen lds
    s_add_u32 s40, s32, 29696
    s_mov_b32 m0, s40
    s_add_u32 s41, s34, 1748992
    buffer_load_dwordx4 v3, s[20:23], s41 offen lds
    s_waitcnt vmcnt(30)
    s_waitcnt lgkmcnt(0)
    ds_read_b64_tr_b16 v[200:201], v5 offset:6144
    ds_read_b64_tr_b16 v[202:203], v5 offset:6656
    ds_read_b64_tr_b16 v[204:205], v6 offset:6144
    ds_read_b64_tr_b16 v[206:207], v6 offset:6656
    v_mfma_f32_32x32x16_bf16 v[64:79], v[192:195], v[144:147], v[64:79]
    v_mfma_f32_32x32x16_bf16 v[80:95], v[192:195], v[148:151], v[80:95]
    v_mfma_f32_32x32x16_bf16 v[96:111], v[196:199], v[144:147], v[96:111]
    v_mfma_f32_32x32x16_bf16 v[112:127], v[196:199], v[148:151], v[112:127]
    s_add_u32 s42, s35, 26624
    buffer_load_dwordx4 v[144:147], v1, s[24:27], s42 offen
    s_add_u32 s42, s36, 26624
    buffer_load_dwordx4 v[148:151], v1, s[24:27], s42 offen
    s_add_u32 s40, s32, 30720
    s_mov_b32 m0, s40
    s_add_u32 s41, s34, 1777664
    buffer_load_dwordx4 v3, s[20:23], s41 offen lds
    s_add_u32 s40, s32, 31744
    s_mov_b32 m0, s40
    s_add_u32 s41, s34, 1806336
    buffer_load_dwordx4 v3, s[20:23], s41 offen lds
    s_waitcnt vmcnt(30)
    s_waitcnt lgkmcnt(0)
    ds_read_b64_tr_b16 v[192:193], v5 offset:8192
    ds_read_b64_tr_b16 v[194:195], v5 offset:8704
    ds_read_b64_tr_b16 v[196:197], v6 offset:8192
    ds_read_b64_tr_b16 v[198:199], v6 offset:8704
    v_mfma_f32_32x32x16_bf16 v[64:79], v[200:203], v[152:155], v[64:79]
    v_mfma_f32_32x32x16_bf16 v[80:95], v[200:203], v[156:159], v[80:95]
    v_mfma_f32_32x32x16_bf16 v[96:111], v[204:207], v[152:155], v[96:111]
    v_mfma_f32_32x32x16_bf16 v[112:127], v[204:207], v[156:159], v[112:127]
    s_add_u32 s42, s35, 27648
    buffer_load_dwordx4 v[152:155], v1, s[24:27], s42 offen
    s_add_u32 s42, s36, 27648
    buffer_load_dwordx4 v[156:159], v1, s[24:27], s42 offen
    s_waitcnt vmcnt(28)
    s_waitcnt lgkmcnt(0)
    ds_read_b64_tr_b16 v[200:201], v5 offset:10240
    ds_read_b64_tr_b16 v[202:203], v5 offset:10752
    ds_read_b64_tr_b16 v[204:205], v6 offset:10240
    ds_read_b64_tr_b16 v[206:207], v6 offset:10752
    v_mfma_f32_32x32x16_bf16 v[64:79], v[192:195], v[160:163], v[64:79]
    v_mfma_f32_32x32x16_bf16 v[80:95], v[192:195], v[164:167], v[80:95]
    v_mfma_f32_32x32x16_bf16 v[96:111], v[196:199], v[160:163], v[96:111]
    v_mfma_f32_32x32x16_bf16 v[112:127], v[196:199], v[164:167], v[112:127]
    s_add_u32 s42, s35, 28672
    buffer_load_dwordx4 v[160:163], v1, s[24:27], s42 offen
    s_add_u32 s42, s36, 28672
    buffer_load_dwordx4 v[164:167], v1, s[24:27], s42 offen
    s_waitcnt vmcnt(26)
    s_waitcnt lgkmcnt(0)
    ds_read_b64_tr_b16 v[192:193], v5 offset:12288
    ds_read_b64_tr_b16 v[194:195], v5 offset:12800
    ds_read_b64_tr_b16 v[196:197], v6 offset:12288
    ds_read_b64_tr_b16 v[198:199], v6 offset:12800
    v_mfma_f32_32x32x16_bf16 v[64:79], v[200:203], v[168:171], v[64:79]
    v_mfma_f32_32x32x16_bf16 v[80:95], v[200:203], v[172:175], v[80:95]
    v_mfma_f32_32x32x16_bf16 v[96:111], v[204:207], v[168:171], v[96:111]
    v_mfma_f32_32x32x16_bf16 v[112:127], v[204:207], v[172:175], v[112:127]
    s_add_u32 s42, s35, 29696
    buffer_load_dwordx4 v[168:171], v1, s[24:27], s42 offen
    s_add_u32 s42, s36, 29696
    buffer_load_dwordx4 v[172:175], v1, s[24:27], s42 offen
    s_waitcnt vmcnt(24)
    s_waitcnt lgkmcnt(0)
    ds_read_b64_tr_b16 v[200:201], v5 offset:14336
    ds_read_b64_tr_b16 v[202:203], v5 offset:14848
    ds_read_b64_tr_b16 v[204:205], v6 offset:14336
    ds_read_b64_tr_b16 v[206:207], v6 offset:14848
    v_mfma_f32_32x32x16_bf16 v[64:79], v[192:195], v[176:179], v[64:79]
    v_mfma_f32_32x32x16_bf16 v[80:95], v[192:195], v[180:183], v[80:95]
    v_mfma_f32_32x32x16_bf16 v[96:111], v[196:199], v[176:179], v[96:111]
    v_mfma_f32_32x32x16_bf16 v[112:127], v[196:199], v[180:183], v[112:127]
    s_add_u32 s42, s35, 30720
    buffer_load_dwordx4 v[176:179], v1, s[24:27], s42 offen
    s_add_u32 s42, s36, 30720
    buffer_load_dwordx4 v[180:183], v1, s[24:27], s42 offen
    s_waitcnt vmcnt(22)
    s_waitcnt lgkmcnt(0)
    ds_read_b64_tr_b16 v[192:193], v5 offset:16384
    ds_read_b64_tr_b16 v[194:195], v5 offset:16896
    ds_read_b64_tr_b16 v[196:197], v6 offset:16384
    ds_read_b64_tr_b16 v[198:199], v6 offset:16896
    v_mfma_f32_32x32x16_bf16 v[64:79], v[200:203], v[184:187], v[64:79]
    v_mfma_f32_32x32x16_bf16 v[80:95], v[200:203], v[188:191], v[80:95]
    v_mfma_f32_32x32x16_bf16 v[96:111], v[204:207], v[184:187], v[96:111]
    v_mfma_f32_32x32x16_bf16 v[112:127], v[204:207], v[188:191], v[112:127]
    s_add_u32 s42, s35, 31744
    buffer_load_dwordx4 v[184:187], v1, s[24:27], s42 offen
    s_add_u32 s42, s36, 31744
    buffer_load_dwordx4 v[188:191], v1, s[24:27], s42 offen
    s_waitcnt vmcnt(20)
    s_waitcnt lgkmcnt(0)
    ds_read_b64_tr_b16 v[200:201], v5 offset:18432
    ds_read_b64_tr_b16 v[202:203], v5 offset:18944
    ds_read_b64_tr_b16 v[204:205], v6 offset:18432
    ds_read_b64_tr_b16 v[206:207], v6 offset:18944
    v_mfma_f32_32x32x16_bf16 v[64:79], v[192:195], v[128:131], v[64:79]
    v_mfma_f32_32x32x16_bf16 v[80:95], v[192:195], v[132:135], v[80:95]
    v_mfma_f32_32x32x16_bf16 v[96:111], v[196:199], v[128:131], v[96:111]
    v_mfma_f32_32x32x16_bf16 v[112:127], v[196:199], v[132:135], v[112:127]
    s_waitcnt vmcnt(16)
    s_waitcnt lgkmcnt(0)
    ds_read_b64_tr_b16 v[192:193], v5 offset:20480
    ds_read_b64_tr_b16 v[194:195], v5 offset:20992
    ds_read_b64_tr_b16 v[196:197], v6 offset:20480
    ds_read_b64_tr_b16 v[198:199], v6 offset:20992
    v_mfma_f32_32x32x16_bf16 v[64:79], v[200:203], v[136:139], v[64:79]
    v_mfma_f32_32x32x16_bf16 v[80:95], v[200:203], v[140:143], v[80:95]
    v_mfma_f32_32x32x16_bf16 v[96:111], v[204:207], v[136:139], v[96:111]
    v_mfma_f32_32x32x16_bf16 v[112:127], v[204:207], v[140:143], v[112:127]
    s_waitcnt vmcnt(12)
    s_waitcnt lgkmcnt(0)
    ds_read_b64_tr_b16 v[200:201], v5 offset:22528
    ds_read_b64_tr_b16 v[202:203], v5 offset:23040
    ds_read_b64_tr_b16 v[204:205], v6 offset:22528
    ds_read_b64_tr_b16 v[206:207], v6 offset:23040
    v_mfma_f32_32x32x16_bf16 v[64:79], v[192:195], v[144:147], v[64:79]
    v_mfma_f32_32x32x16_bf16 v[80:95], v[192:195], v[148:151], v[80:95]
    v_mfma_f32_32x32x16_bf16 v[96:111], v[196:199], v[144:147], v[96:111]
    v_mfma_f32_32x32x16_bf16 v[112:127], v[196:199], v[148:151], v[112:127]
    s_waitcnt vmcnt(8)
    s_waitcnt lgkmcnt(0)
    ds_read_b64_tr_b16 v[192:193], v5 offset:24576
    ds_read_b64_tr_b16 v[194:195], v5 offset:25088
    ds_read_b64_tr_b16 v[196:197], v6 offset:24576
    ds_read_b64_tr_b16 v[198:199], v6 offset:25088
    v_mfma_f32_32x32x16_bf16 v[64:79], v[200:203], v[152:155], v[64:79]
    v_mfma_f32_32x32x16_bf16 v[80:95], v[200:203], v[156:159], v[80:95]
    v_mfma_f32_32x32x16_bf16 v[96:111], v[204:207], v[152:155], v[96:111]
    v_mfma_f32_32x32x16_bf16 v[112:127], v[204:207], v[156:159], v[112:127]
    s_waitcnt vmcnt(6)
    s_waitcnt lgkmcnt(0)
    ds_read_b64_tr_b16 v[200:201], v5 offset:26624
    ds_read_b64_tr_b16 v[202:203], v5 offset:27136
    ds_read_b64_tr_b16 v[204:205], v6 offset:26624
    ds_read_b64_tr_b16 v[206:207], v6 offset:27136
    v_mfma_f32_32x32x16_bf16 v[64:79], v[192:195], v[160:163], v[64:79]
    v_mfma_f32_32x32x16_bf16 v[80:95], v[192:195], v[164:167], v[80:95]
    v_mfma_f32_32x32x16_bf16 v[96:111], v[196:199], v[160:163], v[96:111]
    v_mfma_f32_32x32x16_bf16 v[112:127], v[196:199], v[164:167], v[112:127]
    s_waitcnt vmcnt(4)
    s_waitcnt lgkmcnt(0)
    ds_read_b64_tr_b16 v[192:193], v5 offset:28672
    ds_read_b64_tr_b16 v[194:195], v5 offset:29184
    ds_read_b64_tr_b16 v[196:197], v6 offset:28672
    ds_read_b64_tr_b16 v[198:199], v6 offset:29184
    v_mfma_f32_32x32x16_bf16 v[64:79], v[200:203], v[168:171], v[64:79]
    v_mfma_f32_32x32x16_bf16 v[80:95], v[200:203], v[172:175], v[80:95]
    v_mfma_f32_32x32x16_bf16 v[96:111], v[204:207], v[168:171], v[96:111]
    v_mfma_f32_32x32x16_bf16 v[112:127], v[204:207], v[172:175], v[112:127]
    s_waitcnt vmcnt(2)
    s_waitcnt lgkmcnt(0)
    ds_read_b64_tr_b16 v[200:201], v5 offset:30720
    ds_read_b64_tr_b16 v[202:203], v5 offset:31232
    ds_read_b64_tr_b16 v[204:205], v6 offset:30720
    ds_read_b64_tr_b16 v[206:207], v6 offset:31232
    v_mfma_f32_32x32x16_bf16 v[64:79], v[192:195], v[176:179], v[64:79]
    v_mfma_f32_32x32x16_bf16 v[80:95], v[192:195], v[180:183], v[80:95]
    v_mfma_f32_32x32x16_bf16 v[96:111], v[196:199], v[176:179], v[96:111]
    v_mfma_f32_32x32x16_bf16 v[112:127], v[196:199], v[180:183], v[112:127]
    s_waitcnt vmcnt(0)
    s_waitcnt lgkmcnt(0)
    v_mfma_f32_32x32x16_bf16 v[64:79], v[200:203], v[184:187], v[64:79]
    v_mfma_f32_32x32x16_bf16 v[80:95], v[200:203], v[188:191], v[80:95]
    v_mfma_f32_32x32x16_bf16 v[96:111], v[204:207], v[184:187], v[96:111]
    v_mfma_f32_32x32x16_bf16 v[112:127], v[204:207], v[188:191], v[112:127]
    s_nop 7
    s_nop 7
    v_add_u32 v9, s32, v1
    ds_write_b128 v9, v[64:67] offset:0
    ds_write_b128 v9, v[68:71] offset:1024
    ds_write_b128 v9, v[72:75] offset:2048
    ds_write_b128 v9, v[76:79] offset:3072
    ds_write_b128 v9, v[80:83] offset:4096
    ds_write_b128 v9, v[84:87] offset:5120
    ds_write_b128 v9, v[88:91] offset:6144
    ds_write_b128 v9, v[92:95] offset:7168
    ds_write_b128 v9, v[96:99] offset:8192
    ds_write_b128 v9, v[100:103] offset:9216
    ds_write_b128 v9, v[104:107] offset:10240
    ds_write_b128 v9, v[108:111] offset:11264
    ds_write_b128 v9, v[112:115] offset:12288
    ds_write_b128 v9, v[116:119] offset:13312
    ds_write_b128 v9, v[120:123] offset:14336
    ds_write_b128 v9, v[124:127] offset:15360
    s_waitcnt lgkmcnt(0)
    s_barrier
    s_lshl_b32 s40, s30, 12
    v_add_u32 v9, s40, v1
    v_add_u32 v7, 0x10000, v9
    ds_read_b128 v[128:131], v9 offset:0
    ds_read_b128 v[132:135], v9 offset:1024
    ds_read_b128 v[136:139], v9 offset:2048
    ds_read_b128 v[140:143], v9 offset:3072
    ds_read_b128 v[144:147], v9 offset:32768
    ds_read_b128 v[148:151], v9 offset:33792
    ds_read_b128 v[152:155], v9 offset:34816
    ds_read_b128 v[156:159], v9 offset:35840
    ds_read_b128 v[160:163], v7 offset:0
    ds_read_b128 v[164:167], v7 offset:1024
    ds_read_b128 v[168:171], v7 offset:2048
    ds_read_b128 v[172:175], v7 offset:3072
    ds_read_b128 v[176:179], v7 offset:32768
    ds_read_b128 v[180:183], v7 offset:33792
    ds_read_b128 v[184:187], v7 offset:34816
    ds_read_b128 v[188:191], v7 offset:35840
    s_waitcnt lgkmcnt(0)
    v_add_f32 v128, v128, v144
    v_add_f32 v160, v160, v176
    v_add_f32 v129, v129, v145
    v_add_f32 v161, v161, v177
    v_add_f32 v130, v130, v146
    v_add_f32 v162, v162, v178
    v_add_f32 v131, v131, v147
    v_add_f32 v163, v163, v179
    v_add_f32 v132, v132, v148
    v_add_f32 v164, v164, v180
    v_add_f32 v133, v133, v149
    v_add_f32 v165, v165, v181
    v_add_f32 v134, v134, v150
    v_add_f32 v166, v166, v182
    v_add_f32 v135, v135, v151
    v_add_f32 v167, v167, v183
    v_add_f32 v136, v136, v152
    v_add_f32 v168, v168, v184
    v_add_f32 v137, v137, v153
    v_add_f32 v169, v169, v185
    v_add_f32 v138, v138, v154
    v_add_f32 v170, v170, v186
    v_add_f32 v139, v139, v155
    v_add_f32 v171, v171, v187
    v_add_f32 v140, v140, v156
    v_add_f32 v172, v172, v188
    v_add_f32 v141, v141, v157
    v_add_f32 v173, v173, v189
    v_add_f32 v142, v142, v158
    v_add_f32 v174, v174, v190
    v_add_f32 v143, v143, v159
    v_add_f32 v175, v175, v191
    v_add_f32 v128, v128, v160
    v_add_f32 v129, v129, v161
    v_add_f32 v130, v130, v162
    v_add_f32 v131, v131, v163
    v_add_f32 v132, v132, v164
    v_add_f32 v133, v133, v165
    v_add_f32 v134, v134, v166
    v_add_f32 v135, v135, v167
    v_add_f32 v136, v136, v168
    v_add_f32 v137, v137, v169
    v_add_f32 v138, v138, v170
    v_add_f32 v139, v139, v171
    v_add_f32 v140, v140, v172
    v_add_f32 v141, v141, v173
    v_add_f32 v142, v142, v174
    v_add_f32 v143, v143, v175
    s_lshr_b32 s41, s30, 1
    s_and_b32 s42, s30, 1
    v_lshrrev_b32 v10, 5, v2
    v_lshlrev_b32 v32, 16, v16
    v_and_b32 v33, 0xffff0000, v16
    v_lshlrev_b32 v34, 16, v17
    v_and_b32 v35, 0xffff0000, v17
    v_lshlrev_b32 v36, 16, v18
    v_and_b32 v37, 0xffff0000, v18
    v_lshlrev_b32 v38, 16, v19
    v_and_b32 v39, 0xffff0000, v19
    v_lshlrev_b32 v40, 16, v20
    v_and_b32 v41, 0xffff0000, v20
    v_lshlrev_b32 v42, 16, v21
    v_and_b32 v43, 0xffff0000, v21
    v_lshlrev_b32 v44, 16, v22
    v_and_b32 v45, 0xffff0000, v22
    v_lshlrev_b32 v46, 16, v23
    v_and_b32 v47, 0xffff0000, v23
    v_add_f32 v128, v128, v32
    v_add_f32 v129, v129, v33
    v_add_f32 v130, v130, v34
    v_add_f32 v131, v131, v35
    v_add_f32 v132, v132, v36
    v_add_f32 v133, v133, v37
    v_add_f32 v134, v134, v38
    v_add_f32 v135, v135, v39
    v_add_f32 v136, v136, v40
    v_add_f32 v137, v137, v41
    v_add_f32 v138, v138, v42
    v_add_f32 v139, v139, v43
    v_add_f32 v140, v140, v44
    v_add_f32 v141, v141, v45
    v_add_f32 v142, v142, v46
    v_add_f32 v143, v143, v47
    s_mov_b32 s45, 0xbdd2d3e8
    s_mov_b32 s46, 0xc0135761
    v_mul_f32 v32, v128, v128
    v_mul_f32 v33, v129, v129
    v_mul_f32 v34, v130, v130
    v_mul_f32 v35, v131, v131
    v_mul_f32 v36, v132, v132
    v_mul_f32 v37, v133, v133
    v_mul_f32 v38, v134, v134
    v_mul_f32 v39, v135, v135
    v_mul_f32 v40, v136, v136
    v_mul_f32 v41, v137, v137
    v_mul_f32 v42, v138, v138
    v_mul_f32 v43, v139, v139
    v_mul_f32 v44, v140, v140
    v_mul_f32 v45, v141, v141
    v_mul_f32 v46, v142, v142
    v_mul_f32 v47, v143, v143
    v_mov_b32 v48, s46
    v_mov_b32 v49, s46
    v_mov_b32 v50, s46
    v_mov_b32 v51, s46
    v_mov_b32 v52, s46
    v_mov_b32 v53, s46
    v_mov_b32 v54, s46
    v_mov_b32 v55, s46
    v_mov_b32 v56, s46
    v_mov_b32 v57, s46
    v_mov_b32 v58, s46
    v_mov_b32 v59, s46
    v_mov_b32 v60, s46
    v_mov_b32 v61, s46
    v_mov_b32 v62, s46
    v_mov_b32 v63, s46
    v_fma_f32 v32, v32, s45, v48
    v_fma_f32 v33, v33, s45, v49
    v_fma_f32 v34, v34, s45, v50
    v_fma_f32 v35, v35, s45, v51
    v_fma_f32 v36, v36, s45, v52
    v_fma_f32 v37, v37, s45, v53
    v_fma_f32 v38, v38, s45, v54
    v_fma_f32 v39, v39, s45, v55
    v_fma_f32 v40, v40, s45, v56
    v_fma_f32 v41, v41, s45, v57
    v_fma_f32 v42, v42, s45, v58
    v_fma_f32 v43, v43, s45, v59
    v_fma_f32 v44, v44, s45, v60
    v_fma_f32 v45, v45, s45, v61
    v_fma_f32 v46, v46, s45, v62
    v_fma_f32 v47, v47, s45, v63
    v_mul_f32 v32, v32, v128
    v_mul_f32 v33, v33, v129
    v_mul_f32 v34, v34, v130
    v_mul_f32 v35, v35, v131
    v_mul_f32 v36, v36, v132
    v_mul_f32 v37, v37, v133
    v_mul_f32 v38, v38, v134
    v_mul_f32 v39, v39, v135
    v_mul_f32 v40, v40, v136
    v_mul_f32 v41, v41, v137
    v_mul_f32 v42, v42, v138
    v_mul_f32 v43, v43, v139
    v_mul_f32 v44, v44, v140
    v_mul_f32 v45, v45, v141
    v_mul_f32 v46, v46, v142
    v_mul_f32 v47, v47, v143
    v_exp_f32 v32, v32
    v_exp_f32 v33, v33
    v_exp_f32 v34, v34
    v_exp_f32 v35, v35
    v_exp_f32 v36, v36
    v_exp_f32 v37, v37
    v_exp_f32 v38, v38
    v_exp_f32 v39, v39
    v_exp_f32 v40, v40
    v_exp_f32 v41, v41
    v_exp_f32 v42, v42
    v_exp_f32 v43, v43
    v_exp_f32 v44, v44
    v_exp_f32 v45, v45
    v_exp_f32 v46, v46
    v_exp_f32 v47, v47
    v_add_f32 v32, 1.0, v32
    v_add_f32 v33, 1.0, v33
    v_add_f32 v34, 1.0, v34
    v_add_f32 v35, 1.0, v35
    v_add_f32 v36, 1.0, v36
    v_add_f32 v37, 1.0, v37
    v_add_f32 v38, 1.0, v38
    v_add_f32 v39, 1.0, v39
    v_add_f32 v40, 1.0, v40
    v_add_f32 v41, 1.0, v41
    v_add_f32 v42, 1.0, v42
    v_add_f32 v43, 1.0, v43
    v_add_f32 v44, 1.0, v44
    v_add_f32 v45, 1.0, v45
    v_add_f32 v46, 1.0, v46
    v_add_f32 v47, 1.0, v47
    v_rcp_f32 v32, v32
    v_rcp_f32 v33, v33
    v_rcp_f32 v34, v34
    v_rcp_f32 v35, v35
    v_rcp_f32 v36, v36
    v_rcp_f32 v37, v37
    v_rcp_f32 v38, v38
    v_rcp_f32 v39, v39
    v_rcp_f32 v40, v40
    v_rcp_f32 v41, v41
    v_rcp_f32 v42, v42
    v_rcp_f32 v43, v43
    v_rcp_f32 v44, v44
    v_rcp_f32 v45, v45
    v_rcp_f32 v46, v46
    v_rcp_f32 v47, v47
    s_nop 0
    v_mul_f32 v128, v128, v32
    v_mul_f32 v129, v129, v33
    v_mul_f32 v130, v130, v34
    v_mul_f32 v131, v131, v35
    v_mul_f32 v132, v132, v36
    v_mul_f32 v133, v133, v37
    v_mul_f32 v134, v134, v38
    v_mul_f32 v135, v135, v39
    v_mul_f32 v136, v136, v40
    v_mul_f32 v137, v137, v41
    v_mul_f32 v138, v138, v42
    v_mul_f32 v139, v139, v43
    v_mul_f32 v140, v140, v44
    v_mul_f32 v141, v141, v45
    v_mul_f32 v142, v142, v46
    v_mul_f32 v143, v143, v47
    v_cvt_pk_bf16_f32 v16, v128, v129
    v_cvt_pk_bf16_f32 v17, v130, v131
    v_cvt_pk_bf16_f32 v18, v132, v133
    v_cvt_pk_bf16_f32 v19, v134, v135
    v_cvt_pk_bf16_f32 v20, v136, v137
    v_cvt_pk_bf16_f32 v21, v138, v139
    v_cvt_pk_bf16_f32 v22, v140, v141
    v_cvt_pk_bf16_f32 v23, v142, v143
    s_lshl_b32 s43, s28, 1
    s_add_u32 s43, s43, s42
    s_mul_i32 s43, s43, 112
    s_lshl_b32 s44, s29, 2
    s_lshl_b32 s45, s41, 1
    s_add_u32 s44, s44, s45
    s_add_u32 s43, s43, s44
    s_lshl_b32 s43, s43, 10
    s_add_u32 s43, s43, 8388608
    buffer_store_dwordx4 v[16:19], v1, s[24:27], s43 offen
    buffer_store_dwordx4 v[20:23], v1, s[24:27], s43 offen offset:1024
K4_END:
    s_endpgm
.section .rodata,"a"
.p2align 6
.amdhsa_kernel k4_kernel
  .amdhsa_next_free_vgpr 208
  .amdhsa_next_free_sgpr 102
  .amdhsa_accum_offset 208
  .amdhsa_group_segment_fixed_size 0
  .amdhsa_kernarg_size 104
  .amdhsa_user_sgpr_count 2
  .amdhsa_user_sgpr_kernarg_segment_ptr 1
  .amdhsa_system_sgpr_workgroup_id_x 1
.end_amdhsa_kernel
.text
.globl k5_kernel
.p2align 8
.type k5_kernel,@function
k5_kernel:
    s_cmp_ge_u32 s2, 224
    s_cbranch_scc1 K5_END
    s_load_dwordx2 s[6:7], s[0:1], 64
    s_load_dwordx2 s[8:9], s[0:1], 72
    s_load_dwordx2 s[10:11], s[0:1], 80
    s_load_dwordx2 s[12:13], s[0:1], 96
    v_lshrrev_b32 v1, 6, v0
    v_and_b32 v2, 63, v0
    v_readfirstlane_b32 s30, v1
    s_and_b32 s33, s2, 7
    s_mul_i32 s33, s33, 28
    s_lshr_b32 s34, s2, 3
    s_add_u32 s34, s34, s33
    s_mov_b32 s33, 0x24924925
    s_mul_hi_u32 s29, s34, s33
    s_mul_i32 s33, s29, 7
    s_sub_u32 s28, s34, s33
    s_movk_i32 s31, 4096
    v_lshlrev_b32 v1, 4, v2
    v_lshrrev_b32 v4, 3, v2
    v_mul_lo_u32 v3, v4, s31
    v_bfe_u32 v4, v2, 4, 1
    v_lshlrev_b32 v4, 2, v4
    v_xor_b32 v4, v4, v2
    v_and_b32 v4, 7, v4
    v_lshl_add_u32 v3, v4, 4, v3
    v_lshrrev_b32 v7, 5, v2
    v_lshlrev_b32 v7, 2, v7
    v_bfe_u32 v8, v2, 2, 2
    v_add_u32 v7, v7, v8
    v_lshlrev_b32 v5, 7, v7
    v_bfe_u32 v8, v2, 4, 1
    v_lshl_add_u32 v5, v8, 5, v5
    v_and_b32 v8, 3, v2
    v_lshl_add_u32 v5, v8, 3, v5
    v_bfe_u32 v8, v2, 3, 1
    v_lshlrev_b32 v8, 6, v8
    v_xor_b32 v5, v5, v8
    v_xor_b32 v6, 64, v5
    s_lshl_b32 s32, s30, 15
    v_add_u32 v5, s32, v5
    v_add_u32 v6, s32, v6
    s_lshl_b32 s33, s29, 7
    v_add_u32 v3, s33, v3
    s_waitcnt lgkmcnt(0)
    s_mov_b32 s20, s6
    s_and_b32 s21, s7, 0xffff
    s_mov_b32 s22, 7340032
    s_mov_b32 s23, 0x00020000
    s_mov_b32 s24, s12
    s_and_b32 s25, s13, 0xffff
    s_mov_b32 s26, 67108864
    s_mov_b32 s27, 0x00020000
    s_mul_i32 s34, s30, 1835008
    s_mul_i32 s35, s28, 229376
    s_mul_i32 s36, s30, 28672
    s_add_u32 s35, s35, s36
    s_add_u32 s35, s35, 8388608
    s_add_u32 s36, s35, 114688
    s_lshr_b32 s41, s30, 1
    s_and_b32 s42, s30, 1
    v_lshrrev_b32 v10, 5, v2
    s_mov_b32 s16, s8
    s_and_b32 s17, s9, 0xffff
    s_mov_b32 s18, 4096
    s_mov_b32 s19, 0x00020000
    s_mov_b32 s44, s10
    s_and_b32 s45, s11, 0xffff
    s_mov_b32 s46, 1835008
    s_mov_b32 s47, 0x00020000
    s_lshl_b32 s43, s29, 6
    s_lshl_b32 s48, s41, 5
    s_add_u32 s43, s43, s48
    v_and_b32 v11, 31, v2
    v_add_u32 v11, s43, v11
    v_lshlrev_b32 v12, 1, v11
    buffer_load_ushort v13, v12, s[16:19], 0 offen
    s_movk_i32 s49, 896
    v_mul_lo_u32 v14, v11, s49
    v_lshl_add_u32 v14, v10, 3, v14
    s_lshl_b32 s48, s28, 7
    s_lshl_b32 s49, s42, 6
    s_add_u32 s48, s48, s49
    v_add_u32 v14, s48, v14
    s_lshl_b32 s50, s29, 1
    s_add_u32 s50, s50, s41
    s_mul_i32 s50, s50, 14
    s_lshl_b32 s51, s28, 1
    s_add_u32 s50, s50, s51
    s_add_u32 s50, s50, s42
    s_lshl_b32 s50, s50, 11
    s_add_u32 s50, s50, 4456448
    buffer_load_dwordx4 v[16:19], v1, s[24:27], s50 offen
    buffer_load_dwordx4 v[20:23], v1, s[24:27], s50 offen offset:1024
    s_add_u32 s40, s32, 0
    s_mov_b32 m0, s40
    s_add_u32 s41, s34, 0
    buffer_load_dwordx4 v3, s[20:23], s41 offen lds
    s_add_u32 s40, s32, 1024
    s_mov_b32 m0, s40
    s_add_u32 s41, s34, 32768
    buffer_load_dwordx4 v3, s[20:23], s41 offen lds
    s_add_u32 s40, s32, 2048
    s_mov_b32 m0, s40
    s_add_u32 s41, s34, 65536
    buffer_load_dwordx4 v3, s[20:23], s41 offen lds
    s_add_u32 s40, s32, 3072
    s_mov_b32 m0, s40
    s_add_u32 s41, s34, 98304
    buffer_load_dwordx4 v3, s[20:23], s41 offen lds
    s_add_u32 s40, s32, 4096
    s_mov_b32 m0, s40
    s_add_u32 s41, s34, 131072
    buffer_load_dwordx4 v3, s[20:23], s41 offen lds
    s_add_u32 s40, s32, 5120
    s_mov_b32 m0, s40
    s_add_u32 s41, s34, 163840
    buffer_load_dwordx4 v3, s[20:23], s41 offen lds
    s_add_u32 s40, s32, 6144
    s_mov_b32 m0, s40
    s_add_u32 s41, s34, 196608
    buffer_load_dwordx4 v3, s[20:23], s41 offen lds
    s_add_u32 s40, s32, 7168
    s_mov_b32 m0, s40
    s_add_u32 s41, s34, 229376
    buffer_load_dwordx4 v3, s[20:23], s41 offen lds
    s_add_u32 s40, s32, 8192
    s_mov_b32 m0, s40
    s_add_u32 s41, s34, 262144
    buffer_load_dwordx4 v3, s[20:23], s41 offen lds
    s_add_u32 s40, s32, 9216
    s_mov_b32 m0, s40
    s_add_u32 s41, s34, 294912
    buffer_load_dwordx4 v3, s[20:23], s41 offen lds
    s_add_u32 s42, s35, 0
    buffer_load_dwordx4 v[128:131], v1, s[24:27], s42 offen
    s_add_u32 s42, s36, 0
    buffer_load_dwordx4 v[132:135], v1, s[24:27], s42 offen
    s_add_u32 s40, s32, 10240
    s_mov_b32 m0, s40
    s_add_u32 s41, s34, 327680
    buffer_load_dwordx4 v3, s[20:23], s41 offen lds
    s_add_u32 s40, s32, 11264
    s_mov_b32 m0, s40
    s_add_u32 s41, s34, 360448
    buffer_load_dwordx4 v3, s[20:23], s41 offen lds
    s_add_u32 s42, s35, 1024
    buffer_load_dwordx4 v[136:139], v1, s[24:27], s42 offen
    s_add_u32 s42, s36, 1024
    buffer_load_dwordx4 v[140:143], v1, s[24:27], s42 offen
    s_add_u32 s40, s32, 12288
    s_mov_b32 m0, s40
    s_add_u32 s41, s34, 393216
    buffer_load_dwordx4 v3, s[20:23], s41 offen lds
    s_add_u32 s40, s32, 13312
    s_mov_b32 m0, s40
    s_add_u32 s41, s34, 425984
    buffer_load_dwordx4 v3, s[20:23], s41 offen lds
    s_add_u32 s42, s35, 2048
    buffer_load_dwordx4 v[144:147], v1, s[24:27], s42 offen
    s_add_u32 s42, s36, 2048
    buffer_load_dwordx4 v[148:151], v1, s[24:27], s42 offen
    s_add_u32 s40, s32, 14336
    s_mov_b32 m0, s40
    s_add_u32 s41, s34, 458752
    buffer_load_dwordx4 v3, s[20:23], s41 offen lds
    s_add_u32 s40, s32, 15360
    s_mov_b32 m0, s40
    s_add_u32 s41, s34, 491520
    buffer_load_dwordx4 v3, s[20:23], s41 offen lds
    s_add_u32 s42, s35, 3072
    buffer_load_dwordx4 v[152:155], v1, s[24:27], s42 offen
    s_add_u32 s42, s36, 3072
    buffer_load_dwordx4 v[156:159], v1, s[24:27], s42 offen
    s_add_u32 s40, s32, 16384
    s_mov_b32 m0, s40
    s_add_u32 s41, s34, 524288
    buffer_load_dwordx4 v3, s[20:23], s41 offen lds
    s_add_u32 s40, s32, 17408
    s_mov_b32 m0, s40
    s_add_u32 s41, s34, 557056
    buffer_load_dwordx4 v3, s[20:23], s41 offen lds
    s_add_u32 s42, s35, 4096
    buffer_load_dwordx4 v[160:163], v1, s[24:27], s42 offen
    s_add_u32 s42, s36, 4096
    buffer_load_dwordx4 v[164:167], v1, s[24:27], s42 offen
    s_add_u32 s40, s32, 18432
    s_mov_b32 m0, s40
    s_add_u32 s41, s34, 589824
    buffer_load_dwordx4 v3, s[20:23], s41 offen lds
    s_add_u32 s40, s32, 19456
    s_mov_b32 m0, s40
    s_add_u32 s41, s34, 622592
    buffer_load_dwordx4 v3, s[20:23], s41 offen lds
    s_add_u32 s42, s35, 5120
    buffer_load_dwordx4 v[168:171], v1, s[24:27], s42 offen
    s_add_u32 s42, s36, 5120
    buffer_load_dwordx4 v[172:175], v1, s[24:27], s42 offen
    s_add_u32 s40, s32, 20480
    s_mov_b32 m0, s40
    s_add_u32 s41, s34, 655360
    buffer_load_dwordx4 v3, s[20:23], s41 offen lds
    s_add_u32 s40, s32, 21504
    s_mov_b32 m0, s40
    s_add_u32 s41, s34, 688128
    buffer_load_dwordx4 v3, s[20:23], s41 offen lds
    s_add_u32 s42, s35, 6144
    buffer_load_dwordx4 v[176:179], v1, s[24:27], s42 offen
    s_add_u32 s42, s36, 6144
    buffer_load_dwordx4 v[180:183], v1, s[24:27], s42 offen
    s_add_u32 s40, s32, 22528
    s_mov_b32 m0, s40
    s_add_u32 s41, s34, 720896
    buffer_load_dwordx4 v3, s[20:23], s41 offen lds
    s_add_u32 s40, s32, 23552
    s_mov_b32 m0, s40
    s_add_u32 s41, s34, 753664
    buffer_load_dwordx4 v3, s[20:23], s41 offen lds
    s_add_u32 s42, s35, 7168
    buffer_load_dwordx4 v[184:187], v1, s[24:27], s42 offen
    s_add_u32 s42, s36, 7168
    buffer_load_dwordx4 v[188:191], v1, s[24:27], s42 offen
    s_waitcnt vmcnt(38)
    ds_read_b64_tr_b16 v[192:193], v5 offset:0
    ds_read_b64_tr_b16 v[194:195], v5 offset:1024
    ds_read_b64_tr_b16 v[196:197], v6 offset:0
    ds_read_b64_tr_b16 v[198:199], v6 offset:1024
    s_add_u32 s40, s32, 24576
    s_mov_b32 m0, s40
    s_add_u32 s41, s34, 786432
    buffer_load_dwordx4 v3, s[20:23], s41 offen lds
    s_add_u32 s40, s32, 25600
    s_mov_b32 m0, s40
    s_add_u32 s41, s34, 819200
    buffer_load_dwordx4 v3, s[20:23], s41 offen lds
    s_waitcnt vmcnt(30)
    s_waitcnt lgkmcnt(0)
    ds_read_b64_tr_b16 v[200:201], v5 offset:2048
    ds_read_b64_tr_b16 v[202:203], v5 offset:3072
    ds_read_b64_tr_b16 v[204:205], v6 offset:2048
    ds_read_b64_tr_b16 v[206:207], v6 offset:3072
    v_mfma_f32_32x32x16_bf16 v[64:79], v[128:131], v[192:195], 0
    v_mfma_f32_32x32x16_bf16 v[80:95], v[132:135], v[192:195], 0
    v_mfma_f32_32x32x16_bf16 v[96:111], v[128:131], v[196:199], 0
    v_mfma_f32_32x32x16_bf16 v[112:127], v[132:135], v[196:199], 0
    s_add_u32 s42, s35, 8192
    buffer_load_dwordx4 v[128:131], v1, s[24:27], s42 offen
    s_add_u32 s42, s36, 8192
    buffer_load_dwordx4 v[132:135], v1, s[24:27], s42 offen
    s_add_u32 s40, s32, 26624
    s_mov_b32 m0, s40
    s_add_u32 s41, s34, 851968
    buffer_load_dwordx4 v3, s[20:23], s41 offen lds
    s_add_u32 s40, s32, 27648
    s_mov_b32 m0, s40
    s_add_u32 s41, s34, 884736
    buffer_load_dwordx4 v3, s[20:23], s41 offen lds
    s_waitcnt vmcnt(30)
    s_waitcnt lgkmcnt(0)
    ds_read_b64_tr_b16 v[192:193], v5 offset:4096
    ds_read_b64_tr_b16 v[194:195], v5 offset:5120
    ds_read_b64_tr_b16 v[196:197], v6 offset:4096
    ds_read_b64_tr_b16 v[198:199], v6 offset:5120
    v_mfma_f32_32x32x16_bf16 v[64:79], v[136:139], v[200:203], v[64:79]
    v_mfma_f32_32x32x16_bf16 v[80:95], v[140:143], v[200:203], v[80:95]
    v_mfma_f32_32x32x16_bf16 v[96:111], v[136:139], v[204:207], v[96:111]
    v_mfma_f32_32x32x16_bf16 v[112:127], v[140:143], v[204:207], v[112:127]
    s_add_u32 s42, s35, 9216
    buffer_load_dwordx4 v[136:139], v1, s[24:27], s42 offen
    s_add_u32 s42, s36, 9216
    buffer_load_dwordx4 v[140:143], v1, s[24:27], s42 offen
    s_add_u32 s40, s32, 28672
    s_mov_b32 m0, s40
    s_add_u32 s41, s34, 917504
    buffer_load_dwordx4 v3, s[20:23], s41 offen lds
    s_add_u32 s40, s32, 29696
    s_mov_b32 m0, s40
    s_add_u32 s41, s34, 950272
    buffer_load_dwordx4 v3, s[20:23], s41 offen lds
    s_waitcnt vmcnt(30)
    s_waitcnt lgkmcnt(0)
    ds_read_b64_tr_b16 v[200:201], v5 offset:6144
    ds_read_b64_tr_b16 v[202:203], v5 offset:7168
    ds_read_b64_tr_b16 v[204:205], v6 offset:6144
    ds_read_b64_tr_b16 v[206:207], v6 offset:7168
    v_mfma_f32_32x32x16_bf16 v[64:79], v[144:147], v[192:195], v[64:79]
    v_mfma_f32_32x32x16_bf16 v[80:95], v[148:151], v[192:195], v[80:95]
    v_mfma_f32_32x32x16_bf16 v[96:111], v[144:147], v[196:199], v[96:111]
    v_mfma_f32_32x32x16_bf16 v[112:127], v[148:151], v[196:199], v[112:127]
    s_add_u32 s42, s35, 10240
    buffer_load_dwordx4 v[144:147], v1, s[24:27], s42 offen
    s_add_u32 s42, s36, 10240
    buffer_load_dwordx4 v[148:151], v1, s[24:27], s42 offen
    s_add_u32 s40, s32, 30720
    s_mov_b32 m0, s40
    s_add_u32 s41, s34, 983040
    buffer_load_dwordx4 v3, s[20:23], s41 offen lds
    s_add_u32 s40, s32, 31744
    s_mov_b32 m0, s40
    s_add_u32 s41, s34, 1015808
    buffer_load_dwordx4 v3, s[20:23], s41 offen lds
    s_waitcnt vmcnt(30)
    s_waitcnt lgkmcnt(0)
    ds_read_b64_tr_b16 v[192:193], v5 offset:8192
    ds_read_b64_tr_b16 v[194:195], v5 offset:9216
    ds_read_b64_tr_b16 v[196:197], v6 offset:8192
    ds_read_b64_tr_b16 v[198:199], v6 offset:9216
    v_mfma_f32_32x32x16_bf16 v[64:79], v[152:155], v[200:203], v[64:79]
    v_mfma_f32_32x32x16_bf16 v[80:95], v[156:159], v[200:203], v[80:95]
    v_mfma_f32_32x32x16_bf16 v[96:111], v[152:155], v[204:207], v[96:111]
    v_mfma_f32_32x32x16_bf16 v[112:127], v[156:159], v[204:207], v[112:127]
    s_add_u32 s42, s35, 11264
    buffer_load_dwordx4 v[152:155], v1, s[24:27], s42 offen
    s_add_u32 s42, s36, 11264
    buffer_load_dwordx4 v[156:159], v1, s[24:27], s42 offen
    s_add_u32 s40, s32, 0
    s_mov_b32 m0, s40
    s_add_u32 s41, s34, 1048576
    buffer_load_dwordx4 v3, s[20:23], s41 offen lds
    s_add_u32 s40, s32, 1024
    s_mov_b32 m0, s40
    s_add_u32 s41, s34, 1081344
    buffer_load_dwordx4 v3, s[20:23], s41 offen lds
    s_waitcnt vmcnt(30)
    s_waitcnt lgkmcnt(0)
    ds_read_b64_tr_b16 v[200:201], v5 offset:10240
    ds_read_b64_tr_b16 v[202:203], v5 offset:11264
    ds_read_b64_tr_b16 v[204:205], v6 offset:10240
    ds_read_b64_tr_b16 v[206:207], v6 offset:11264
    v_mfma_f32_32x32x16_bf16 v[64:79], v[160:163], v[192:195], v[64:79]
    v_mfma_f32_32x32x16_bf16 v[80:95], v[164:167], v[192:195], v[80:95]
    v_mfma_f32_32x32x16_bf16 v[96:111], v[160:163], v[196:199], v[96:111]
    v_mfma_f32_32x32x16_bf16 v[112:127], v[164:167], v[196:199], v[112:127]
    s_add_u32 s42, s35, 12288
    buffer_load_dwordx4 v[160:163], v1, s[24:27], s42 offen
    s_add_u32 s42, s36, 12288
    buffer_load_dwordx4 v[164:167], v1, s[24:27], s42 offen
    s_add_u32 s40, s32, 2048
    s_mov_b32 m0, s40
    s_add_u32 s41, s34, 1114112
    buffer_load_dwordx4 v3, s[20:23], s41 offen lds
    s_add_u32 s40, s32, 3072
    s_mov_b32 m0, s40
    s_add_u32 s41, s34, 1146880
    buffer_load_dwordx4 v3, s[20:23], s41 offen lds
    s_waitcnt vmcnt(30)
    s_waitcnt lgkmcnt(0)
    ds_read_b64_tr_b16 v[192:193], v5 offset:12288
    ds_read_b64_tr_b16 v[194:195], v5 offset:13312
    ds_read_b64_tr_b16 v[196:197], v6 offset:12288
    ds_read_b64_tr_b16 v[198:199], v6 offset:13312
    v_mfma_f32_32x32x16_bf16 v[64:79], v[168:171], v[200:203], v[64:79]
    v_mfma_f32_32x32x16_bf16 v[80:95], v[172:175], v[200:203], v[80:95]
    v_mfma_f32_32x32x16_bf16 v[96:111], v[168:171], v[204:207], v[96:111]
    v_mfma_f32_32x32x16_bf16 v[112:127], v[172:175], v[204:207], v[112:127]
    s_add_u32 s42, s35, 13312
    buffer_load_dwordx4 v[168:171], v1, s[24:27], s42 offen
    s_add_u32 s42, s36, 13312
    buffer_load_dwordx4 v[172:175], v1, s[24:27], s42 offen
    s_add_u32 s40, s32, 4096
    s_mov_b32 m0, s40
    s_add_u32 s41, s34, 1179648
    buffer_load_dwordx4 v3, s[20:23], s41 offen lds
    s_add_u32 s40, s32, 5120
    s_mov_b32 m0, s40
    s_add_u32 s41, s34, 1212416
    buffer_load_dwordx4 v3, s[20:23], s41 offen lds
    s_waitcnt vmcnt(30)
    s_waitcnt lgkmcnt(0)
    ds_read_b64_tr_b16 v[200:201], v5 offset:14336
    ds_read_b64_tr_b16 v[202:203], v5 offset:15360
    ds_read_b64_tr_b16 v[204:205], v6 offset:14336
    ds_read_b64_tr_b16 v[206:207], v6 offset:15360
    v_mfma_f32_32x32x16_bf16 v[64:79], v[176:179], v[192:195], v[64:79]
    v_mfma_f32_32x32x16_bf16 v[80:95], v[180:183], v[192:195], v[80:95]
    v_mfma_f32_32x32x16_bf16 v[96:111], v[176:179], v[196:199], v[96:111]
    v_mfma_f32_32x32x16_bf16 v[112:127], v[180:183], v[196:199], v[112:127]
    s_add_u32 s42, s35, 14336
    buffer_load_dwordx4 v[176:179], v1, s[24:27], s42 offen
    s_add_u32 s42, s36, 14336
    buffer_load_dwordx4 v[180:183], v1, s[24:27], s42 offen
    s_add_u32 s40, s32, 6144
    s_mov_b32 m0, s40
    s_add_u32 s41, s34, 1245184
    buffer_load_dwordx4 v3, s[20:23], s41 offen lds
    s_add_u32 s40, s32, 7168
    s_mov_b32 m0, s40
    s_add_u32 s41, s34, 1277952
    buffer_load_dwordx4 v3, s[20:23], s41 offen lds
    s_waitcnt vmcnt(30)
    s_waitcnt lgkmcnt(0)
    ds_read_b64_tr_b16 v[192:193], v5 offset:16384
    ds_read_b64_tr_b16 v[194:195], v5 offset:17408
    ds_read_b64_tr_b16 v[196:197], v6 offset:16384
    ds_read_b64_tr_b16 v[198:199], v6 offset:17408
    v_mfma_f32_32x32x16_bf16 v[64:79], v[184:187], v[200:203], v[64:79]
    v_mfma_f32_32x32x16_bf16 v[80:95], v[188:191], v[200:203], v[80:95]
    v_mfma_f32_32x32x16_bf16 v[96:111], v[184:187], v[204:207], v[96:111]
    v_mfma_f32_32x32x16_bf16 v[112:127], v[188:191], v[204:207], v[112:127]
    s_add_u32 s42, s35, 15360
    buffer_load_dwordx4 v[184:187], v1, s[24:27], s42 offen
    s_add_u32 s42, s36, 15360
    buffer_load_dwordx4 v[188:191], v1, s[24:27], s42 offen
    s_add_u32 s40, s32, 8192
    s_mov_b32 m0, s40
    s_add_u32 s41, s34, 1310720
    buffer_load_dwordx4 v3, s[20:23], s41 offen lds
    s_add_u32 s40, s32, 9216
    s_mov_b32 m0, s40
    s_add_u32 s41, s34, 1343488
    buffer_load_dwordx4 v3, s[20:23], s41 offen lds
    s_waitcnt vmcnt(30)
    s_waitcnt lgkmcnt(0)
    ds_read_b64_tr_b16 v[200:201], v5 offset:18432
    ds_read_b64_tr_b16 v[202:203], v5 offset:19456
    ds_read_b64_tr_b16 v[204:205], v6 offset:18432
    ds_read_b64_tr_b16 v[206:207], v6 offset:19456
    v_mfma_f32_32x32x16_bf16 v[64:79], v[128:131], v[192:195], v[64:79]
    v_mfma_f32_32x32x16_bf16 v[80:95], v[132:135], v[192:195], v[80:95]
    v_mfma_f32_32x32x16_bf16 v[96:111], v[128:131], v[196:199], v[96:111]
    v_mfma_f32_32x32x16_bf16 v[112:127], v[132:135], v[196:199], v[112:127]
    s_add_u32 s42, s35, 16384
    buffer_load_dwordx4 v[128:131], v1, s[24:27], s42 offen
    s_add_u32 s42, s36, 16384
    buffer_load_dwordx4 v[132:135], v1, s[24:27], s42 offen
    s_add_u32 s40, s32, 10240
    s_mov_b32 m0, s40
    s_add_u32 s41, s34, 1376256
    buffer_load_dwordx4 v3, s[20:23], s41 offen lds
    s_add_u32 s40, s32, 11264
    s_mov_b32 m0, s40
    s_add_u32 s41, s34, 1409024
    buffer_load_dwordx4 v3, s[20:23], s41 offen lds
    s_waitcnt vmcnt(30)
    s_waitcnt lgkmcnt(0)
    ds_read_b64_tr_b16 v[192:193], v5 offset:20480
    ds_read_b64_tr_b16 v[194:195], v5 offset:21504
    ds_read_b64_tr_b16 v[196:197], v6 offset:20480
    ds_read_b64_tr_b16 v[198:199], v6 offset:21504
    v_mfma_f32_32x32x16_bf16 v[64:79], v[136:139], v[200:203], v[64:79]
    v_mfma_f32_32x32x16_bf16 v[80:95], v[140:143], v[200:203], v[80:95]
    v_mfma_f32_32x32x16_bf16 v[96:111], v[136:139], v[204:207], v[96:111]
    v_mfma_f32_32x32x16_bf16 v[112:127], v[140:143], v[204:207], v[112:127]
    s_add_u32 s42, s35, 17408
    buffer_load_dwordx4 v[136:139], v1, s[24:27], s42 offen
    s_add_u32 s42, s36, 17408
    buffer_load_dwordx4 v[140:143], v1, s[24:27], s42 offen
    s_add_u32 s40, s32, 12288
    s_mov_b32 m0, s40
    s_add_u32 s41, s34, 1441792
    buffer_load_dwordx4 v3, s[20:23], s41 offen lds
    s_add_u32 s40, s32, 13312
    s_mov_b32 m0, s40
    s_add_u32 s41, s34, 1474560
    buffer_load_dwordx4 v3, s[20:23], s41 offen lds
    s_waitcnt vmcnt(30)
    s_waitcnt lgkmcnt(0)
    ds_read_b64_tr_b16 v[200:201], v5 offset:22528
    ds_read_b64_tr_b16 v[202:203], v5 offset:23552
    ds_read_b64_tr_b16 v[204:205], v6 offset:22528
    ds_read_b64_tr_b16 v[206:207], v6 offset:23552
    v_mfma_f32_32x32x16_bf16 v[64:79], v[144:147], v[192:195], v[64:79]
    v_mfma_f32_32x32x16_bf16 v[80:95], v[148:151], v[192:195], v[80:95]
    v_mfma_f32_32x32x16_bf16 v[96:111], v[144:147], v[196:199], v[96:111]
    v_mfma_f32_32x32x16_bf16 v[112:127], v[148:151], v[196:199], v[112:127]
    s_add_u32 s42, s35, 18432
    buffer_load_dwordx4 v[144:147], v1, s[24:27], s42 offen
    s_add_u32 s42, s36, 18432
    buffer_load_dwordx4 v[148:151], v1, s[24:27], s42 offen
    s_add_u32 s40, s32, 14336
    s_mov_b32 m0, s40
    s_add_u32 s41, s34, 1507328
    buffer_load_dwordx4 v3, s[20:23], s41 offen lds
    s_add_u32 s40, s32, 15360
    s_mov_b32 m0, s40
    s_add_u32 s41, s34, 1540096
    buffer_load_dwordx4 v3, s[20:23], s41 offen lds
    s_waitcnt vmcnt(30)
    s_waitcnt lgkmcnt(0)
    ds_read_b64_tr_b16 v[192:193], v5 offset:24576
    ds_read_b64_tr_b16 v[194:195], v5 offset:25600
    ds_read_b64_tr_b16 v[196:197], v6 offset:24576
    ds_read_b64_tr_b16 v[198:199], v6 offset:25600
    v_mfma_f32_32x32x16_bf16 v[64:79], v[152:155], v[200:203], v[64:79]
    v_mfma_f32_32x32x16_bf16 v[80:95], v[156:159], v[200:203], v[80:95]
    v_mfma_f32_32x32x16_bf16 v[96:111], v[152:155], v[204:207], v[96:111]
    v_mfma_f32_32x32x16_bf16 v[112:127], v[156:159], v[204:207], v[112:127]
    s_add_u32 s42, s35, 19456
    buffer_load_dwordx4 v[152:155], v1, s[24:27], s42 offen
    s_add_u32 s42, s36, 19456
    buffer_load_dwordx4 v[156:159], v1, s[24:27], s42 offen
    s_add_u32 s40, s32, 16384
    s_mov_b32 m0, s40
    s_add_u32 s41, s34, 1572864
    buffer_load_dwordx4 v3, s[20:23], s41 offen lds
    s_add_u32 s40, s32, 17408
    s_mov_b32 m0, s40
    s_add_u32 s41, s34, 1605632
    buffer_load_dwordx4 v3, s[20:23], s41 offen lds
    s_waitcnt vmcnt(30)
    s_waitcnt lgkmcnt(0)
    ds_read_b64_tr_b16 v[200:201], v5 offset:26624
    ds_read_b64_tr_b16 v[202:203], v5 offset:27648
    ds_read_b64_tr_b16 v[204:205], v6 offset:26624
    ds_read_b64_tr_b16 v[206:207], v6 offset:27648
    v_mfma_f32_32x32x16_bf16 v[64:79], v[160:163], v[192:195], v[64:79]
    v_mfma_f32_32x32x16_bf16 v[80:95], v[164:167], v[192:195], v[80:95]
    v_mfma_f32_32x32x16_bf16 v[96:111], v[160:163], v[196:199], v[96:111]
    v_mfma_f32_32x32x16_bf16 v[112:127], v[164:167], v[196:199], v[112:127]
    s_add_u32 s42, s35, 20480
    buffer_load_dwordx4 v[160:163], v1, s[24:27], s42 offen
    s_add_u32 s42, s36, 20480
    buffer_load_dwordx4 v[164:167], v1, s[24:27], s42 offen
    s_add_u32 s40, s32, 18432
    s_mov_b32 m0, s40
    s_add_u32 s41, s34, 1638400
    buffer_load_dwordx4 v3, s[20:23], s41 offen lds
    s_add_u32 s40, s32, 19456
    s_mov_b32 m0, s40
    s_add_u32 s41, s34, 1671168
    buffer_load_dwordx4 v3, s[20:23], s41 offen lds
    s_waitcnt vmcnt(30)
    s_waitcnt lgkmcnt(0)
    ds_read_b64_tr_b16 v[192:193], v5 offset:28672
    ds_read_b64_tr_b16 v[194:195], v5 offset:29696
    ds_read_b64_tr_b16 v[196:197], v6 offset:28672
    ds_read_b64_tr_b16 v[198:199], v6 offset:29696
    v_mfma_f32_32x32x16_bf16 v[64:79], v[168:171], v[200:203], v[64:79]
    v_mfma_f32_32x32x16_bf16 v[80:95], v[172:175], v[200:203], v[80:95]
    v_mfma_f32_32x32x16_bf16 v[96:111], v[168:171], v[204:207], v[96:111]
    v_mfma_f32_32x32x16_bf16 v[112:127], v[172:175], v[204:207], v[112:127]
    s_add_u32 s42, s35, 21504
    buffer_load_dwordx4 v[168:171], v1, s[24:27], s42 offen
    s_add_u32 s42, s36, 21504
    buffer_load_dwordx4 v[172:175], v1, s[24:27], s42 offen
    s_add_u32 s40, s32, 20480
    s_mov_b32 m0, s40
    s_add_u32 s41, s34, 1703936
    buffer_load_dwordx4 v3, s[20:23], s41 offen lds
    s_add_u32 s40, s32, 21504
    s_mov_b32 m0, s40
    s_add_u32 s41, s34, 1736704
    buffer_load_dwordx4 v3, s[20:23], s41 offen lds
    s_waitcnt vmcnt(30)
    s_waitcnt lgkmcnt(0)
    ds_read_b64_tr_b16 v[200:201], v5 offset:30720
    ds_read_b64_tr_b16 v[202:203], v5 offset:31744
    ds_read_b64_tr_b16 v[204:205], v6 offset:30720
    ds_read_b64_tr_b16 v[206:207], v6 offset:31744
    v_mfma_f32_32x32x16_bf16 v[64:79], v[176:179], v[192:195], v[64:79]
    v_mfma_f32_32x32x16_bf16 v[80:95], v[180:183], v[192:195], v[80:95]
    v_mfma_f32_32x32x16_bf16 v[96:111], v[176:179], v[196:199], v[96:111]
    v_mfma_f32_32x32x16_bf16 v[112:127], v[180:183], v[196:199], v[112:127]
    s_add_u32 s42, s35, 22528
    buffer_load_dwordx4 v[176:179], v1, s[24:27], s42 offen
    s_add_u32 s42, s36, 22528
    buffer_load_dwordx4 v[180:183], v1, s[24:27], s42 offen
    s_add_u32 s40, s32, 22528
    s_mov_b32 m0, s40
    s_add_u32 s41, s34, 1769472
    buffer_load_dwordx4 v3, s[20:23], s41 offen lds
    s_add_u32 s40, s32, 23552
    s_mov_b32 m0, s40
    s_add_u32 s41, s34, 1802240
    buffer_load_dwordx4 v3, s[20:23], s41 offen lds
    s_waitcnt vmcnt(30)
    s_waitcnt lgkmcnt(0)
    ds_read_b64_tr_b16 v[192:193], v5 offset:0
    ds_read_b64_tr_b16 v[194:195], v5 offset:1024
    ds_read_b64_tr_b16 v[196:197], v6 offset:0
    ds_read_b64_tr_b16 v[198:199], v6 offset:1024
    v_mfma_f32_32x32x16_bf16 v[64:79], v[184:187], v[200:203], v[64:79]
    v_mfma_f32_32x32x16_bf16 v[80:95], v[188:191], v[200:203], v[80:95]
    v_mfma_f32_32x32x16_bf16 v[96:111], v[184:187], v[204:207], v[96:111]
    v_mfma_f32_32x32x16_bf16 v[112:127], v[188:191], v[204:207], v[112:127]
    s_add_u32 s42, s35, 23552
    buffer_load_dwordx4 v[184:187], v1, s[24:27], s42 offen
    s_add_u32 s42, s36, 23552
    buffer_load_dwordx4 v[188:191], v1, s[24:27], s42 offen
    s_waitcnt vmcnt(28)
    s_waitcnt lgkmcnt(0)
    ds_read_b64_tr_b16 v[200:201], v5 offset:2048
    ds_read_b64_tr_b16 v[202:203], v5 offset:3072
    ds_read_b64_tr_b16 v[204:205], v6 offset:2048
    ds_read_b64_tr_b16 v[206:207], v6 offset:3072
    v_mfma_f32_32x32x16_bf16 v[64:79], v[128:131], v[192:195], v[64:79]
    v_mfma_f32_32x32x16_bf16 v[80:95], v[132:135], v[192:195], v[80:95]
    v_mfma_f32_32x32x16_bf16 v[96:111], v[128:131], v[196:199], v[96:111]
    v_mfma_f32_32x32x16_bf16 v[112:127], v[132:135], v[196:199], v[112:127]
    s_add_u32 s42, s35, 24576
    buffer_load_dwordx4 v[128:131], v1, s[24:27], s42 offen
    s_add_u32 s42, s36, 24576
    buffer_load_dwordx4 v[132:135], v1, s[24:27], s42 offen
    s_waitcnt vmcnt(26)
    s_waitcnt lgkmcnt(0)
    ds_read_b64_tr_b16 v[192:193], v5 offset:4096
    ds_read_b64_tr_b16 v[194:195], v5 offset:5120
    ds_read_b64_tr_b16 v[196:197], v6 offset:4096
    ds_read_b64_tr_b16 v[198:199], v6 offset:5120
    v_mfma_f32_32x32x16_bf16 v[64:79], v[136:139], v[200:203], v[64:79]
    v_mfma_f32_32x32x16_bf16 v[80:95], v[140:143], v[200:203], v[80:95]
    v_mfma_f32_32x32x16_bf16 v[96:111], v[136:139], v[204:207], v[96:111]
    v_mfma_f32_32x32x16_bf16 v[112:127], v[140:143], v[204:207], v[112:127]
    s_add_u32 s42, s35, 25600
    buffer_load_dwordx4 v[136:139], v1, s[24:27], s42 offen
    s_add_u32 s42, s36, 25600
    buffer_load_dwordx4 v[140:143], v1, s[24:27], s42 offen
    s_waitcnt vmcnt(24)
    s_waitcnt lgkmcnt(0)
    ds_read_b64_tr_b16 v[200:201], v5 offset:6144
    ds_read_b64_tr_b16 v[202:203], v5 offset:7168
    ds_read_b64_tr_b16 v[204:205], v6 offset:6144
    ds_read_b64_tr_b16 v[206:207], v6 offset:7168
    v_mfma_f32_32x32x16_bf16 v[64:79], v[144:147], v[192:195], v[64:79]
    v_mfma_f32_32x32x16_bf16 v[80:95], v[148:151], v[192:195], v[80:95]
    v_mfma_f32_32x32x16_bf16 v[96:111], v[144:147], v[196:199], v[96:111]
    v_mfma_f32_32x32x16_bf16 v[112:127], v[148:151], v[196:199], v[112:127]
    s_add_u32 s42, s35, 26624
    buffer_load_dwordx4 v[144:147], v1, s[24:27], s42 offen
    s_add_u32 s42, s36, 26624
    buffer_load_dwordx4 v[148:151], v1, s[24:27], s42 offen
    s_waitcnt vmcnt(22)
    s_waitcnt lgkmcnt(0)
    ds_read_b64_tr_b16 v[192:193], v5 offset:8192
    ds_read_b64_tr_b16 v[194:195], v5 offset:9216
    ds_read_b64_tr_b16 v[196:197], v6 offset:8192
    ds_read_b64_tr_b16 v[198:199], v6 offset:9216
    v_mfma_f32_32x32x16_bf16 v[64:79], v[152:155], v[200:203], v[64:79]
    v_mfma_f32_32x32x16_bf16 v[80:95], v[156:159], v[200:203], v[80:95]
    v_mfma_f32_32x32x16_bf16 v[96:111], v[152:155], v[204:207], v[96:111]
    v_mfma_f32_32x32x16_bf16 v[112:127], v[156:159], v[204:207], v[112:127]
    s_add_u32 s42, s35, 27648
    buffer_load_dwordx4 v[152:155], v1, s[24:27], s42 offen
    s_add_u32 s42, s36, 27648
    buffer_load_dwordx4 v[156:159], v1, s[24:27], s42 offen
    s_waitcnt vmcnt(20)
    s_waitcnt lgkmcnt(0)
    ds_read_b64_tr_b16 v[200:201], v5 offset:10240
    ds_read_b64_tr_b16 v[202:203], v5 offset:11264
    ds_read_b64_tr_b16 v[204:205], v6 offset:10240
    ds_read_b64_tr_b16 v[206:207], v6 offset:11264
    v_mfma_f32_32x32x16_bf16 v[64:79], v[160:163], v[192:195], v[64:79]
    v_mfma_f32_32x32x16_bf16 v[80:95], v[164:167], v[192:195], v[80:95]
    v_mfma_f32_32x32x16_bf16 v[96:111], v[160:163], v[196:199], v[96:111]
    v_mfma_f32_32x32x16_bf16 v[112:127], v[164:167], v[196:199], v[112:127]
    s_waitcnt vmcnt(16)
    s_waitcnt lgkmcnt(0)
    ds_read_b64_tr_b16 v[192:193], v5 offset:12288
    ds_read_b64_tr_b16 v[194:195], v5 offset:13312
    ds_read_b64_tr_b16 v[196:197], v6 offset:12288
    ds_read_b64_tr_b16 v[198:199], v6 offset:13312
    v_mfma_f32_32x32x16_bf16 v[64:79], v[168:171], v[200:203], v[64:79]
    v_mfma_f32_32x32x16_bf16 v[80:95], v[172:175], v[200:203], v[80:95]
    v_mfma_f32_32x32x16_bf16 v[96:111], v[168:171], v[204:207], v[96:111]
    v_mfma_f32_32x32x16_bf16 v[112:127], v[172:175], v[204:207], v[112:127]
    s_waitcnt vmcnt(12)
    s_waitcnt lgkmcnt(0)
    ds_read_b64_tr_b16 v[200:201], v5 offset:14336
    ds_read_b64_tr_b16 v[202:203], v5 offset:15360
    ds_read_b64_tr_b16 v[204:205], v6 offset:14336
    ds_read_b64_tr_b16 v[206:207], v6 offset:15360
    v_mfma_f32_32x32x16_bf16 v[64:79], v[176:179], v[192:195], v[64:79]
    v_mfma_f32_32x32x16_bf16 v[80:95], v[180:183], v[192:195], v[80:95]
    v_mfma_f32_32x32x16_bf16 v[96:111], v[176:179], v[196:199], v[96:111]
    v_mfma_f32_32x32x16_bf16 v[112:127], v[180:183], v[196:199], v[112:127]
    s_waitcnt vmcnt(8)
    s_waitcnt lgkmcnt(0)
    ds_read_b64_tr_b16 v[192:193], v5 offset:16384
    ds_read_b64_tr_b16 v[194:195], v5 offset:17408
    ds_read_b64_tr_b16 v[196:197], v6 offset:16384
    ds_read_b64_tr_b16 v[198:199], v6 offset:17408
    v_mfma_f32_32x32x16_bf16 v[64:79], v[184:187], v[200:203], v[64:79]
    v_mfma_f32_32x32x16_bf16 v[80:95], v[188:191], v[200:203], v[80:95]
    v_mfma_f32_32x32x16_bf16 v[96:111], v[184:187], v[204:207], v[96:111]
    v_mfma_f32_32x32x16_bf16 v[112:127], v[188:191], v[204:207], v[112:127]
    s_waitcnt vmcnt(6)
    s_waitcnt lgkmcnt(0)
    ds_read_b64_tr_b16 v[200:201], v5 offset:18432
    ds_read_b64_tr_b16 v[202:203], v5 offset:19456
    ds_read_b64_tr_b16 v[204:205], v6 offset:18432
    ds_read_b64_tr_b16 v[206:207], v6 offset:19456
    v_mfma_f32_32x32x16_bf16 v[64:79], v[128:131], v[192:195], v[64:79]
    v_mfma_f32_32x32x16_bf16 v[80:95], v[132:135], v[192:195], v[80:95]
    v_mfma_f32_32x32x16_bf16 v[96:111], v[128:131], v[196:199], v[96:111]
    v_mfma_f32_32x32x16_bf16 v[112:127], v[132:135], v[196:199], v[112:127]
    s_waitcnt vmcnt(4)
    s_waitcnt lgkmcnt(0)
    ds_read_b64_tr_b16 v[192:193], v5 offset:20480
    ds_read_b64_tr_b16 v[194:195], v5 offset:21504
    ds_read_b64_tr_b16 v[196:197], v6 offset:20480
    ds_read_b64_tr_b16 v[198:199], v6 offset:21504
    v_mfma_f32_32x32x16_bf16 v[64:79], v[136:139], v[200:203], v[64:79]
    v_mfma_f32_32x32x16_bf16 v[80:95], v[140:143], v[200:203], v[80:95]
    v_mfma_f32_32x32x16_bf16 v[96:111], v[136:139], v[204:207], v[96:111]
    v_mfma_f32_32x32x16_bf16 v[112:127], v[140:143], v[204:207], v[112:127]
    s_waitcnt vmcnt(2)
    s_waitcnt lgkmcnt(0)
    ds_read_b64_tr_b16 v[200:201], v5 offset:22528
    ds_read_b64_tr_b16 v[202:203], v5 offset:23552
    ds_read_b64_tr_b16 v[204:205], v6 offset:22528
    ds_read_b64_tr_b16 v[206:207], v6 offset:23552
    v_mfma_f32_32x32x16_bf16 v[64:79], v[144:147], v[192:195], v[64:79]
    v_mfma_f32_32x32x16_bf16 v[80:95], v[148:151], v[192:195], v[80:95]
    v_mfma_f32_32x32x16_bf16 v[96:111], v[144:147], v[196:199], v[96:111]
    v_mfma_f32_32x32x16_bf16 v[112:127], v[148:151], v[196:199], v[112:127]
    s_waitcnt vmcnt(0)
    s_waitcnt lgkmcnt(0)
    v_mfma_f32_32x32x16_bf16 v[64:79], v[152:155], v[200:203], v[64:79]
    v_mfma_f32_32x32x16_bf16 v[80:95], v[156:159], v[200:203], v[80:95]
    v_mfma_f32_32x32x16_bf16 v[96:111], v[152:155], v[204:207], v[96:111]
    v_mfma_f32_32x32x16_bf16 v[112:127], v[156:159], v[204:207], v[112:127]
    s_nop 7
    s_nop 7
    v_add_u32 v9, s32, v1
    ds_write_b128 v9, v[64:67] offset:0
    ds_write_b128 v9, v[68:71] offset:1024
    ds_write_b128 v9, v[72:75] offset:2048
    ds_write_b128 v9, v[76:79] offset:3072
    ds_write_b128 v9, v[80:83] offset:4096
    ds_write_b128 v9, v[84:87] offset:5120
    ds_write_b128 v9, v[88:91] offset:6144
    ds_write_b128 v9, v[92:95] offset:7168
    ds_write_b128 v9, v[96:99] offset:8192
    ds_write_b128 v9, v[100:103] offset:9216
    ds_write_b128 v9, v[104:107] offset:10240
    ds_write_b128 v9, v[108:111] offset:11264
    ds_write_b128 v9, v[112:115] offset:12288
    ds_write_b128 v9, v[116:119] offset:13312
    ds_write_b128 v9, v[120:123] offset:14336
    ds_write_b128 v9, v[124:127] offset:15360
    s_waitcnt lgkmcnt(0)
    s_barrier
    s_lshl_b32 s40, s30, 12
    v_add_u32 v9, s40, v1
    v_add_u32 v7, 0x10000, v9
    ds_read_b128 v[128:131], v9 offset:0
    ds_read_b128 v[132:135], v9 offset:1024
    ds_read_b128 v[136:139], v9 offset:2048
    ds_read_b128 v[140:143], v9 offset:3072
    ds_read_b128 v[144:147], v9 offset:32768
    ds_read_b128 v[148:151], v9 offset:33792
    ds_read_b128 v[152:155], v9 offset:34816
    ds_read_b128 v[156:159], v9 offset:35840
    ds_read_b128 v[160:163], v7 offset:0
    ds_read_b128 v[164:167], v7 offset:1024
    ds_read_b128 v[168:171], v7 offset:2048
    ds_read_b128 v[172:175], v7 offset:3072
    ds_read_b128 v[176:179], v7 offset:32768
    ds_read_b128 v[180:183], v7 offset:33792
    ds_read_b128 v[184:187], v7 offset:34816
    ds_read_b128 v[188:191], v7 offset:35840
    s_waitcnt lgkmcnt(0)
    v_add_f32 v128, v128, v144
    v_add_f32 v160, v160, v176
    v_add_f32 v129, v129, v145
    v_add_f32 v161, v161, v177
    v_add_f32 v130, v130, v146
    v_add_f32 v162, v162, v178
    v_add_f32 v131, v131, v147
    v_add_f32 v163, v163, v179
    v_add_f32 v132, v132, v148
    v_add_f32 v164, v164, v180
    v_add_f32 v133, v133, v149
    v_add_f32 v165, v165, v181
    v_add_f32 v134, v134, v150
    v_add_f32 v166, v166, v182
    v_add_f32 v135, v135, v151
    v_add_f32 v167, v167, v183
    v_add_f32 v136, v136, v152
    v_add_f32 v168, v168, v184
    v_add_f32 v137, v137, v153
    v_add_f32 v169, v169, v185
    v_add_f32 v138, v138, v154
    v_add_f32 v170, v170, v186
    v_add_f32 v139, v139, v155
    v_add_f32 v171, v171, v187
    v_add_f32 v140, v140, v156
    v_add_f32 v172, v172, v188
    v_add_f32 v141, v141, v157
    v_add_f32 v173, v173, v189
    v_add_f32 v142, v142, v158
    v_add_f32 v174, v174, v190
    v_add_f32 v143, v143, v159
    v_add_f32 v175, v175, v191
    v_add_f32 v128, v128, v160
    v_add_f32 v129, v129, v161
    v_add_f32 v130, v130, v162
    v_add_f32 v131, v131, v163
    v_add_f32 v132, v132, v164
    v_add_f32 v133, v133, v165
    v_add_f32 v134, v134, v166
    v_add_f32 v135, v135, v167
    v_add_f32 v136, v136, v168
    v_add_f32 v137, v137, v169
    v_add_f32 v138, v138, v170
    v_add_f32 v139, v139, v171
    v_add_f32 v140, v140, v172
    v_add_f32 v141, v141, v173
    v_add_f32 v142, v142, v174
    v_add_f32 v143, v143, v175
    s_lshr_b32 s41, s30, 1
    s_and_b32 s42, s30, 1
    v_lshrrev_b32 v10, 5, v2
    v_lshlrev_b32 v13, 16, v13
    v_add_f32 v128, v128, v13
    v_add_f32 v129, v129, v13
    v_add_f32 v130, v130, v13
    v_add_f32 v131, v131, v13
    v_add_f32 v132, v132, v13
    v_add_f32 v133, v133, v13
    v_add_f32 v134, v134, v13
    v_add_f32 v135, v135, v13
    v_add_f32 v136, v136, v13
    v_add_f32 v137, v137, v13
    v_add_f32 v138, v138, v13
    v_add_f32 v139, v139, v13
    v_add_f32 v140, v140, v13
    v_add_f32 v141, v141, v13
    v_add_f32 v142, v142, v13
    v_add_f32 v143, v143, v13
    v_cvt_pk_bf16_f32 v24, v128, v129
    v_cvt_pk_bf16_f32 v25, v130, v131
    v_cvt_pk_bf16_f32 v26, v132, v133
    v_cvt_pk_bf16_f32 v27, v134, v135
    v_cvt_pk_bf16_f32 v28, v136, v137
    v_cvt_pk_bf16_f32 v29, v138, v139
    v_cvt_pk_bf16_f32 v30, v140, v141
    v_cvt_pk_bf16_f32 v31, v142, v143
    v_lshlrev_b32 v128, 16, v24
    v_and_b32 v129, 0xffff0000, v24
    v_lshlrev_b32 v32, 16, v16
    v_and_b32 v33, 0xffff0000, v16
    v_lshlrev_b32 v130, 16, v25
    v_and_b32 v131, 0xffff0000, v25
    v_lshlrev_b32 v34, 16, v17
    v_and_b32 v35, 0xffff0000, v17
    v_lshlrev_b32 v132, 16, v26
    v_and_b32 v133, 0xffff0000, v26
    v_lshlrev_b32 v36, 16, v18
    v_and_b32 v37, 0xffff0000, v18
    v_lshlrev_b32 v134, 16, v27
    v_and_b32 v135, 0xffff0000, v27
    v_lshlrev_b32 v38, 16, v19
    v_and_b32 v39, 0xffff0000, v19
    v_lshlrev_b32 v136, 16, v28
    v_and_b32 v137, 0xffff0000, v28
    v_lshlrev_b32 v40, 16, v20
    v_and_b32 v41, 0xffff0000, v20
    v_lshlrev_b32 v138, 16, v29
    v_and_b32 v139, 0xffff0000, v29
    v_lshlrev_b32 v42, 16, v21
    v_and_b32 v43, 0xffff0000, v21
    v_lshlrev_b32 v140, 16, v30
    v_and_b32 v141, 0xffff0000, v30
    v_lshlrev_b32 v44, 16, v22
    v_and_b32 v45, 0xffff0000, v22
    v_lshlrev_b32 v142, 16, v31
    v_and_b32 v143, 0xffff0000, v31
    v_lshlrev_b32 v46, 16, v23
    v_and_b32 v47, 0xffff0000, v23
    v_add_f32 v128, v128, v32
    v_add_f32 v129, v129, v33
    v_add_f32 v130, v130, v34
    v_add_f32 v131, v131, v35
    v_add_f32 v132, v132, v36
    v_add_f32 v133, v133, v37
    v_add_f32 v134, v134, v38
    v_add_f32 v135, v135, v39
    v_add_f32 v136, v136, v40
    v_add_f32 v137, v137, v41
    v_add_f32 v138, v138, v42
    v_add_f32 v139, v139, v43
    v_add_f32 v140, v140, v44
    v_add_f32 v141, v141, v45
    v_add_f32 v142, v142, v46
    v_add_f32 v143, v143, v47
    v_cvt_pk_bf16_f32 v24, v128, v129
    v_cvt_pk_bf16_f32 v25, v130, v131
    v_cvt_pk_bf16_f32 v26, v132, v133
    v_cvt_pk_bf16_f32 v27, v134, v135
    v_cvt_pk_bf16_f32 v28, v136, v137
    v_cvt_pk_bf16_f32 v29, v138, v139
    v_cvt_pk_bf16_f32 v30, v140, v141
    v_cvt_pk_bf16_f32 v31, v142, v143
    buffer_store_dwordx2 v[24:25], v14, s[44:47], 0 offen offset:0
    buffer_store_dwordx2 v[26:27], v14, s[44:47], 0 offen offset:16
    buffer_store_dwordx2 v[28:29], v14, s[44:47], 0 offen offset:32
    buffer_store_dwordx2 v[30:31], v14, s[44:47], 0 offen offset:48
K5_END:
    s_endpgm
.section .rodata,"a"
.p2align 6
.amdhsa_kernel k5_kernel
  .amdhsa_next_free_vgpr 208
  .amdhsa_next_free_sgpr 102
  .amdhsa_accum_offset 208
  .amdhsa_group_segment_fixed_size 0
  .amdhsa_kernarg_size 104
  .amdhsa_user_sgpr_count 2
  .amdhsa_user_sgpr_kernarg_segment_ptr 1
  .amdhsa_system_sgpr_workgroup_id_x 1
.end_amdhsa_kernel
.text
```
